```python
import torch

def _softmax(x, axis=-1):
    return torch.softmax(x, dim=axis)
def _gelu(x):
    return torch.nn.functional.gelu(x, approximate="tanh")
def _silu(x):
    return torch.nn.functional.silu(x)
def _sigmoid(x):
    return torch.sigmoid(x)
def _layernorm(x, axis=-1, eps=1e-5):
    m = x.mean(dim=axis, keepdim=True)
    v = x.var(dim=axis, keepdim=True, unbiased=False)
    return (x - m) / torch.sqrt(v + eps)
def _scatter_add(tgt, idx, src, axis=0):
    return tgt.clone().index_add_(axis, idx, src)
def _segment_sum(src, seg, n):
    out = torch.zeros((n,) + src.shape[1:], dtype=src.dtype)
    return out.index_add_(0, seg, src)
def _pad(x, pw):
    flat = tuple(v for pair in reversed(pw) for v in pair)
    return torch.nn.functional.pad(x, flat)

kernel_name = 'concat_heads__mha_block__sliding_local_dilated__prompt'

def setup_inputs():

    _w = (lambda a: (lambda t: t.to(torch.bfloat16) if t.is_floating_point() else t)(torch.as_tensor(a)))
    def _A_setup():
        B, S, D, H = 1, 2048, 512, 32
        return {
            "x": _w((lambda *s: torch.randn(*s, dtype=torch.bfloat16) * 0.2)(B, S, D)),
            "wqkv": _w((lambda *s: torch.randn(*s, dtype=torch.bfloat16) * 0.4)(D, 3 * D)),
            "wo": _w((lambda *s: torch.randn(*s, dtype=torch.bfloat16) * 0.1)(D, D)),
        }
    _A_in = _A_setup()

    def _B_setup():
        B, S, D = 1, 2048, 512
        return {
            "x": _w((lambda *s: torch.randn(*s, dtype=torch.bfloat16) * 0.4)(B, S, D)),
            "wqkv": _w((lambda *s: torch.randn(*s, dtype=torch.bfloat16) * 0.4)(D, 3 * D)),
            "wo": _w((lambda *s: torch.randn(*s, dtype=torch.bfloat16) * 0.05)(D, D)),
        }
    _B_in = _B_setup()

    return {
        "A_x": _A_in["x"],
        "A_wqkv": _A_in["wqkv"],
        "A_wo": _A_in["wo"],
        "B_x": _B_in["x"],
        "B_wqkv": _B_in["wqkv"],
        "B_wo": _B_in["wo"],
    }

def reference(A_x, A_wqkv, A_wo, B_x, B_wqkv, B_wo):
    def _A_ref(x, wqkv, wo):
        B, S, D = x.shape
        H = 32
        Dh = D // H
        qkv = (lambda x, *d: x.permute(*d))((x @ wqkv).reshape(B, S, 3, H, Dh), 2, 0, 3, 1, 4)
        q, k, v = qkv[0], qkv[1], qkv[2]
        scores = torch.einsum("bhqd,bhkd->bhqk", q, k) * (Dh ** -0.5)
        p = _softmax(scores, axis=-1)
        o = torch.einsum("bhqk,bhkd->bhqd", p, v)
        return (lambda x, *d: x.permute(*d))(o, 0, 2, 1, 3).reshape(B, S, D) @ wo

    def _B_ref(x, wqkv, wo):
        B, S, D = x.shape
        H = 32; Dh = D // H
        W, dil = 8, 2
        qkv = (lambda x, *d: x.permute(*d))((x @ wqkv).reshape(B, S, 3, H, Dh), 2, 0, 3, 1, 4)
        q, k, v = qkv[0], qkv[1], qkv[2]
        scale = Dh ** -0.5
        pos = torch.arange(S)
        off = torch.arange(W) * dil
        idx = pos[:, None] - off[None, :]
        mask = idx >= 0
        idx_c = torch.where(mask, idx, 0).reshape(-1)
        kg = k[:, :, idx_c, :].reshape(B, H, S, W, Dh)
        vg = v[:, :, idx_c, :].reshape(B, H, S, W, Dh)
        logits = torch.einsum("bhsd,bhswd->bhsw", q, kg) * scale
        logits = torch.where(mask[None, None, :, :], logits, -1e9)
        attn = _softmax(logits, axis=-1)
        o = torch.einsum("bhsw,bhswd->bhsd", attn, vg)
        return (lambda x, *d: x.permute(*d))(o, 0, 2, 1, 3).reshape(B, S, D) @ wo

    a = _A_ref(A_x, A_wqkv, A_wo)
    b = _B_ref(B_x, B_wqkv, B_wo)
    return torch.concatenate([a, b], axis=-1)
```

```asm
; @launch grid=(256,1,1) block=(512,1,1) lds=163840
.amdgcn_target "amdgcn-amd-amdhsa--gfx950"
.text
.globl concat_heads__mha_block__sliding_local_dilated__prompt_kernel
.p2align 8
.type concat_heads__mha_block__sliding_local_dilated__prompt_kernel,@function
concat_heads__mha_block__sliding_local_dilated__prompt_kernel:
    s_cmp_ge_u32 s2, 256
    s_cbranch_scc1 F_DONE

    s_load_dwordx4 s[24:27], s[0:1], 0
    s_load_dwordx2 s[38:39], s[0:1], 16
    s_load_dwordx2 s[42:43], s[0:1], 24
    s_load_dwordx2 s[44:45], s[0:1], 32
    s_load_dwordx2 s[40:41], s[0:1], 40
    s_load_dwordx2 s[36:37], s[0:1], 48
    s_load_dwordx2 s[34:35], s[0:1], 56
    s_load_dwordx2 s[32:33], s[0:1], 64
    v_lshrrev_b32 v1, 6, v0
    v_and_b32 v0, 63, v0
    s_and_b32 s3, s2, 7
    v_readfirstlane_b32 s20, v1
    s_lshr_b32 s4, s2, 3
    s_and_b32 s5, s3, 3
    s_lshl_b32 s5, s5, 3
    s_lshr_b32 s6, s4, 2
    s_add_u32 s48, s5, s6
    s_lshr_b32 s5, s3, 2
    s_lshl_b32 s5, s5, 2
    s_and_b32 s47, s4, 3
    s_lshl_b32 s49, s47, 1
    s_add_u32 s49, s49, s6
    s_and_b32 s49, s49, 7
    s_add_u32 s47, s47, s5
    s_and_b32 s5, s47, 3
    s_cmp_eq_u32 s5, 3
    s_cselect_b32 s5, 4, 0
    s_xor_b32 s47, s47, s5
    s_mov_b32 s7, s47

    s_lshl_b32 s5, s3, 2
    s_and_b32 s6, s4, 3
    s_add_u32 s50, s5, s6
    s_lshr_b32 s51, s4, 2
    s_lshl_b32 s5, s3, 2
    s_lshr_b32 s6, s4, 3
    s_add_u32 s52, s5, s6
    s_and_b32 s53, s4, 7
    v_lshlrev_b32 v1, 4, v0
    s_mov_b32 s54, 0x0000ffff
    s_mov_b32 s55, 0x0000ffff
    s_and_b32 s21, s20, 3
    s_lshl_b32 s22, s48, 6
    s_lshl_b32 s23, s21, 3
    s_add_u32 s22, s22, s23
    v_lshrrev_b32 v4, 3, v0
    v_add_u32 v5, s22, v4
    v_lshlrev_b32 v5, 10, v5
    s_and_b32 s22, s21, 1
    s_lshl_b32 s22, s22, 2
    v_lshrrev_b32 v6, 4, v0
    v_add_u32 v7, s22, v6
    v_and_b32 v7, 7, v7
    v_and_b32 v8, 7, v0
    v_xor_b32 v7, v7, v8
    v_lshlrev_b32 v7, 4, v7
    v_add_u32 v240, v5, v7
    s_lshl_b32 s22, s21, 3
    v_add_u32 v5, s22, v4
    s_movk_i32 s23, 3072
    v_mul_lo_u32 v5, v5, s23
    s_lshl_b32 s22, s7, 7
    v_add_u32 v5, s22, v5
    v_lshrrev_b32 v7, 2, v8
    v_and_b32 v10, 1, v6
    v_xor_b32 v7, v7, v10
    v_lshlrev_b32 v7, 6, v7
    v_add_u32 v5, v5, v7
    v_and_b32 v7, 3, v0
    v_lshlrev_b32 v7, 4, v7
    v_add_u32 v241, v5, v7
    s_sub_u32 s22, s47, s7
    s_lshl_b32 s22, s22, 7
    v_add_u32 v242, s22, v241
    s_waitcnt lgkmcnt(0)

    s_mov_b32 s8, s24
    s_and_b32 s9, s25, 0xffff
    s_mov_b32 s10, 0x200000
    s_mov_b32 s11, 0x00020000
    s_mov_b32 s12, s26
    s_and_b32 s13, s27, 0xffff
    s_mov_b32 s14, 0x180000
    s_mov_b32 s15, 0x00020000
    s_mov_b32 s16, s32
    s_and_b32 s17, s33, 0xffff
    s_mov_b32 s18, 0x1210000
    s_mov_b32 s19, 0x00020000
    s_mov_b32 s28, s34
    s_and_b32 s29, s35, 0xffff
    s_mov_b32 s30, 256
    s_mov_b32 s31, 0x00020000

    v_and_b32 v3, 15, v0
    v_lshlrev_b32 v3, 4, v3
    v_lshrrev_b32 v4, 5, v0
    v_lshlrev_b32 v4, 8, v4
    v_add_u32 v250, v3, v4
    s_cmp_ge_u32 s20, 4
    s_cbranch_scc1 F_LOADER

    s_and_b32 s58, s20, 1
    s_lshr_b32 s59, s20, 1
    v_and_b32 v4, 31, v0
    v_lshrrev_b32 v5, 5, v0
    s_lshl_b32 s21, s58, 5
    v_add_u32 v6, s21, v4
    v_lshlrev_b32 v6, 7, v6
    v_lshrrev_b32 v7, 1, v4
    v_and_b32 v7, 7, v7
    v_xor_b32 v7, v7, v5
    v_lshlrev_b32 v7, 4, v7
    v_add_u32 v6, v6, v7
    v_add_u32 v12, 65536, v6
    v_xor_b32 v13, 32, v6
    v_add_u32 v13, 65536, v13
    v_xor_b32 v14, 64, v6
    v_add_u32 v14, 65536, v14
    v_xor_b32 v15, 0x60, v6
    v_add_u32 v15, 65536, v15
    v_bfe_u32 v6, v0, 2, 2
    v_lshlrev_b32 v7, 3, v5
    v_add_u32 v7, v7, v6
    v_lshlrev_b32 v7, 7, v7
    v_lshrrev_b32 v8, 1, v6
    v_xor_b32 v8, s59, v8
    v_lshlrev_b32 v8, 6, v8
    v_add_u32 v7, v7, v8
    v_bfe_u32 v8, v0, 4, 1
    v_lshlrev_b32 v8, 5, v8
    v_add_u32 v7, v7, v8
    v_and_b32 v8, 3, v0
    v_lshlrev_b32 v8, 3, v8
    v_add_u32 v7, v7, v8
    v_add_u32 v16, 73728, v7
    v_and_b32 v17, 0x33, v0
    v_bfe_u32 v18, v0, 2, 1
    v_lshlrev_b32 v18, 3, v18
    v_or_b32 v17, v17, v18
    v_bfe_u32 v18, v0, 3, 1
    v_lshlrev_b32 v18, 2, v18
    v_or_b32 v17, v17, v18
    v_lshlrev_b32 v17, 4, v17
    v_bfe_u32 v10, v0, 4, 1
    v_lshlrev_b32 v18, 16, v10
    v_add_u32 v18, v18, v250
    v_lshlrev_b32 v19, 11, v10
    v_add_u32 v19, v19, v250
    s_lshl_b32 s21, s48, 1
    s_add_u32 s60, s21, s58
    s_lshl_b32 s61, s7, 2
    s_lshl_b32 s21, s59, 1
    s_add_u32 s61, s61, s21
    s_lshl_b32 s21, s61, 16
    s_lshl_b32 s22, s60, 10
    s_add_u32 s62, s21, s22

    s_mov_b32 s8, s42
    s_and_b32 s9, s43, 0xffff
    s_mov_b32 s10, 0x200000
    s_mov_b32 s11, 0x00020000
    s_mov_b32 s12, s44
    s_and_b32 s13, s45, 0xffff
    s_mov_b32 s14, 0x180000
    s_mov_b32 s15, 0x00020000
    s_and_b32 s21, s48, 7
    s_lshl_b32 s21, s21, 2
    s_and_b32 s22, s47, 3
    s_add_u32 s21, s21, s22
    s_lshr_b32 s22, s48, 3
    s_lshl_b32 s22, s22, 9
    s_lshl_b32 s23, s21, 4
    s_add_u32 s22, s22, s23
    s_lshl_b32 s63, s22, 10
    v_lshlrev_b32 v52, 7, v0
    s_lshl_b32 s23, s21, 4
    v_lshrrev_b32 v53, 2, v0
    v_add_u32 v53, s23, v53
    v_mul_u32_u24 v53, 3072, v53
    v_and_b32 v54, 3, v0
    v_lshlrev_b32 v54, 7, v54
    v_add_u32 v53, v53, v54
    s_lshr_b32 s23, s47, 2
    s_lshl_b32 s23, s23, 9
    v_add_u32 v53, s23, v53

    s_mov_b32 s27, 0x3eb8aa3b
    s_barrier
    ds_read_b128 v[20:23], v12
    ds_read_b64_tr_b16 v[24:25], v16 offset:0
    ds_read_b64_tr_b16 v[26:27], v16 offset:512
    ds_read_b64_tr_b16 v[28:29], v16 offset:8192
    ds_read_b64_tr_b16 v[30:31], v16 offset:8704
    ds_read_b64_tr_b16 v[32:33], v16 offset:16384
    ds_read_b64_tr_b16 v[34:35], v16 offset:16896
    s_waitcnt lgkmcnt(4)
    v_mfma_f32_32x32x16_bf16 v[64:79], v[24:27], v[20:23], 0
    ds_read_b128 v[36:39], v13
    ds_read_b64_tr_b16 v[40:41], v16 offset:2048
    s_waitcnt lgkmcnt(4)
    v_mfma_f32_32x32x16_bf16 v[80:95], v[28:31], v[20:23], 0
    ds_read_b64_tr_b16 v[42:43], v16 offset:2560
    ds_read_b64_tr_b16 v[44:45], v16 offset:10240
    s_waitcnt lgkmcnt(4)
    v_mfma_f32_32x32x16_bf16 v[96:111], v[20:23], v[32:35], 0
    ds_read_b64_tr_b16 v[46:47], v16 offset:10752
    ds_read_b64_tr_b16 v[48:49], v16 offset:18432
    ds_read_b64_tr_b16 v[50:51], v16 offset:18944
    s_waitcnt lgkmcnt(4)
    v_mfma_f32_32x32x16_bf16 v[64:79], v[40:43], v[36:39], v[64:79]
    ds_read_b128 v[20:23], v14
    ds_read_b64_tr_b16 v[24:25], v16 offset:4096
    s_waitcnt lgkmcnt(4)
    v_mfma_f32_32x32x16_bf16 v[80:95], v[44:47], v[36:39], v[80:95]
    ds_read_b64_tr_b16 v[26:27], v16 offset:4608
    ds_read_b64_tr_b16 v[28:29], v16 offset:12288
    s_waitcnt lgkmcnt(4)
    v_mfma_f32_32x32x16_bf16 v[96:111], v[36:39], v[48:51], v[96:111]
    ds_read_b64_tr_b16 v[30:31], v16 offset:12800
    ds_read_b64_tr_b16 v[32:33], v16 offset:20480
    ds_read_b64_tr_b16 v[34:35], v16 offset:20992
    s_waitcnt lgkmcnt(4)
    v_mfma_f32_32x32x16_bf16 v[64:79], v[24:27], v[20:23], v[64:79]
    ds_read_b128 v[36:39], v15
    ds_read_b64_tr_b16 v[40:41], v16 offset:6144
    s_waitcnt lgkmcnt(4)
    v_mfma_f32_32x32x16_bf16 v[80:95], v[28:31], v[20:23], v[80:95]
    ds_read_b64_tr_b16 v[42:43], v16 offset:6656
    ds_read_b64_tr_b16 v[44:45], v16 offset:14336
    s_waitcnt lgkmcnt(4)
    v_mfma_f32_32x32x16_bf16 v[96:111], v[20:23], v[32:35], v[96:111]
    ds_read_b64_tr_b16 v[46:47], v16 offset:14848
    ds_read_b64_tr_b16 v[48:49], v16 offset:22528
    ds_read_b64_tr_b16 v[50:51], v16 offset:23040
    s_waitcnt lgkmcnt(4)
    v_mfma_f32_32x32x16_bf16 v[64:79], v[40:43], v[36:39], v[64:79]
    s_waitcnt lgkmcnt(2)
    v_mfma_f32_32x32x16_bf16 v[80:95], v[44:47], v[36:39], v[80:95]
    s_waitcnt lgkmcnt(0)
    s_barrier
    v_add_u32 v12, 32768, v12
    v_add_u32 v13, 32768, v13
    v_add_u32 v14, 32768, v14
    v_add_u32 v15, 32768, v15
    v_add_u32 v16, 32768, v16
    ds_read_b128 v[20:23], v12
    ds_read_b64_tr_b16 v[24:25], v16 offset:0
    ds_read_b64_tr_b16 v[26:27], v16 offset:512
    v_mfma_f32_32x32x16_bf16 v[96:111], v[36:39], v[48:51], v[96:111]
    ds_read_b64_tr_b16 v[28:29], v16 offset:8192
    ds_read_b64_tr_b16 v[30:31], v16 offset:8704
    ds_read_b64_tr_b16 v[32:33], v16 offset:16384
    ds_read_b64_tr_b16 v[34:35], v16 offset:16896
    s_waitcnt lgkmcnt(4)
    v_mfma_f32_32x32x16_bf16 v[64:79], v[24:27], v[20:23], v[64:79]
    ds_read_b128 v[36:39], v13
    ds_read_b64_tr_b16 v[40:41], v16 offset:2048
    s_waitcnt lgkmcnt(4)
    v_mfma_f32_32x32x16_bf16 v[80:95], v[28:31], v[20:23], v[80:95]
    ds_read_b64_tr_b16 v[42:43], v16 offset:2560
    ds_read_b64_tr_b16 v[44:45], v16 offset:10240
    s_waitcnt lgkmcnt(4)
    v_mfma_f32_32x32x16_bf16 v[96:111], v[20:23], v[32:35], v[96:111]
    ds_read_b64_tr_b16 v[46:47], v16 offset:10752
    ds_read_b64_tr_b16 v[48:49], v16 offset:18432
    ds_read_b64_tr_b16 v[50:51], v16 offset:18944
    s_waitcnt lgkmcnt(4)
    v_mfma_f32_32x32x16_bf16 v[64:79], v[40:43], v[36:39], v[64:79]
    ds_read_b128 v[20:23], v14
    ds_read_b64_tr_b16 v[24:25], v16 offset:4096
    s_waitcnt lgkmcnt(4)
    v_mfma_f32_32x32x16_bf16 v[80:95], v[44:47], v[36:39], v[80:95]
    ds_read_b64_tr_b16 v[26:27], v16 offset:4608
    ds_read_b64_tr_b16 v[28:29], v16 offset:12288
    s_waitcnt lgkmcnt(4)
    v_mfma_f32_32x32x16_bf16 v[96:111], v[36:39], v[48:51], v[96:111]
    ds_read_b64_tr_b16 v[30:31], v16 offset:12800
    ds_read_b64_tr_b16 v[32:33], v16 offset:20480
    ds_read_b64_tr_b16 v[34:35], v16 offset:20992
    s_waitcnt lgkmcnt(4)
    v_mfma_f32_32x32x16_bf16 v[64:79], v[24:27], v[20:23], v[64:79]
    ds_read_b128 v[36:39], v15
    ds_read_b64_tr_b16 v[40:41], v16 offset:6144
    s_waitcnt lgkmcnt(4)
    v_mfma_f32_32x32x16_bf16 v[80:95], v[28:31], v[20:23], v[80:95]
    ds_read_b64_tr_b16 v[42:43], v16 offset:6656
    ds_read_b64_tr_b16 v[44:45], v16 offset:14336
    s_waitcnt lgkmcnt(4)
    v_mfma_f32_32x32x16_bf16 v[96:111], v[20:23], v[32:35], v[96:111]
    ds_read_b64_tr_b16 v[46:47], v16 offset:14848
    ds_read_b64_tr_b16 v[48:49], v16 offset:22528
    ds_read_b64_tr_b16 v[50:51], v16 offset:23040
    s_waitcnt lgkmcnt(4)
    v_mfma_f32_32x32x16_bf16 v[64:79], v[40:43], v[36:39], v[64:79]
    s_waitcnt lgkmcnt(2)
    v_mfma_f32_32x32x16_bf16 v[80:95], v[44:47], v[36:39], v[80:95]
    s_waitcnt lgkmcnt(0)
    s_barrier
    v_add_u32 v12, 32768, v12
    v_add_u32 v13, 32768, v13
    v_add_u32 v14, 32768, v14
    v_add_u32 v15, 32768, v15
    v_add_u32 v16, 32768, v16
    ds_read_b128 v[20:23], v12
    ds_read_b64_tr_b16 v[24:25], v16 offset:0
    ds_read_b64_tr_b16 v[26:27], v16 offset:512
    v_mfma_f32_32x32x16_bf16 v[96:111], v[36:39], v[48:51], v[96:111]
    ds_read_b64_tr_b16 v[28:29], v16 offset:8192
    ds_read_b64_tr_b16 v[30:31], v16 offset:8704
    ds_read_b64_tr_b16 v[32:33], v16 offset:16384
    ds_read_b64_tr_b16 v[34:35], v16 offset:16896
    s_waitcnt lgkmcnt(4)
    v_mfma_f32_32x32x16_bf16 v[64:79], v[24:27], v[20:23], v[64:79]
    ds_read_b128 v[36:39], v13
    ds_read_b64_tr_b16 v[40:41], v16 offset:2048
    s_waitcnt lgkmcnt(4)
    v_mfma_f32_32x32x16_bf16 v[80:95], v[28:31], v[20:23], v[80:95]
    ds_read_b64_tr_b16 v[42:43], v16 offset:2560
    ds_read_b64_tr_b16 v[44:45], v16 offset:10240
    s_waitcnt lgkmcnt(4)
    v_mfma_f32_32x32x16_bf16 v[96:111], v[20:23], v[32:35], v[96:111]
    ds_read_b64_tr_b16 v[46:47], v16 offset:10752
    ds_read_b64_tr_b16 v[48:49], v16 offset:18432
    ds_read_b64_tr_b16 v[50:51], v16 offset:18944
    s_waitcnt lgkmcnt(4)
    v_mfma_f32_32x32x16_bf16 v[64:79], v[40:43], v[36:39], v[64:79]
    ds_read_b128 v[20:23], v14
    ds_read_b64_tr_b16 v[24:25], v16 offset:4096
    s_waitcnt lgkmcnt(4)
    v_mfma_f32_32x32x16_bf16 v[80:95], v[44:47], v[36:39], v[80:95]
    ds_read_b64_tr_b16 v[26:27], v16 offset:4608
    ds_read_b64_tr_b16 v[28:29], v16 offset:12288
    s_waitcnt lgkmcnt(4)
    v_mfma_f32_32x32x16_bf16 v[96:111], v[36:39], v[48:51], v[96:111]
    ds_read_b64_tr_b16 v[30:31], v16 offset:12800
    ds_read_b64_tr_b16 v[32:33], v16 offset:20480
    ds_read_b64_tr_b16 v[34:35], v16 offset:20992
    s_waitcnt lgkmcnt(4)
    v_mfma_f32_32x32x16_bf16 v[64:79], v[24:27], v[20:23], v[64:79]
    ds_read_b128 v[36:39], v15
    ds_read_b64_tr_b16 v[40:41], v16 offset:6144
    s_waitcnt lgkmcnt(4)
    v_mfma_f32_32x32x16_bf16 v[80:95], v[28:31], v[20:23], v[80:95]
    ds_read_b64_tr_b16 v[42:43], v16 offset:6656
    ds_read_b64_tr_b16 v[44:45], v16 offset:14336
    s_waitcnt lgkmcnt(4)
    v_mfma_f32_32x32x16_bf16 v[96:111], v[20:23], v[32:35], v[96:111]
    ds_read_b64_tr_b16 v[46:47], v16 offset:14848
    ds_read_b64_tr_b16 v[48:49], v16 offset:22528
    ds_read_b64_tr_b16 v[50:51], v16 offset:23040
    s_waitcnt lgkmcnt(4)
    v_mfma_f32_32x32x16_bf16 v[64:79], v[40:43], v[36:39], v[64:79]
    s_waitcnt lgkmcnt(2)
    v_mfma_f32_32x32x16_bf16 v[80:95], v[44:47], v[36:39], v[80:95]
    s_waitcnt lgkmcnt(0)
    s_barrier
    v_add_u32 v12, -65536, v12
    v_add_u32 v13, -65536, v13
    v_add_u32 v14, -65536, v14
    v_add_u32 v15, -65536, v15
    v_add_u32 v16, -65536, v16
    ds_read_b128 v[20:23], v12
    ds_read_b64_tr_b16 v[24:25], v16 offset:0
    ds_read_b64_tr_b16 v[26:27], v16 offset:512
    v_mfma_f32_32x32x16_bf16 v[96:111], v[36:39], v[48:51], v[96:111]
    ds_read_b64_tr_b16 v[28:29], v16 offset:8192
    ds_read_b64_tr_b16 v[30:31], v16 offset:8704
    ds_read_b64_tr_b16 v[32:33], v16 offset:16384
    ds_read_b64_tr_b16 v[34:35], v16 offset:16896
    s_waitcnt lgkmcnt(4)
    v_mfma_f32_32x32x16_bf16 v[64:79], v[24:27], v[20:23], v[64:79]
    ds_read_b128 v[36:39], v13
    ds_read_b64_tr_b16 v[40:41], v16 offset:2048
    s_waitcnt lgkmcnt(4)
    v_mfma_f32_32x32x16_bf16 v[80:95], v[28:31], v[20:23], v[80:95]
    ds_read_b64_tr_b16 v[42:43], v16 offset:2560
    ds_read_b64_tr_b16 v[44:45], v16 offset:10240
    s_waitcnt lgkmcnt(4)
    v_mfma_f32_32x32x16_bf16 v[96:111], v[20:23], v[32:35], v[96:111]
    ds_read_b64_tr_b16 v[46:47], v16 offset:10752
    ds_read_b64_tr_b16 v[48:49], v16 offset:18432
    ds_read_b64_tr_b16 v[50:51], v16 offset:18944
    s_waitcnt lgkmcnt(4)
    v_mfma_f32_32x32x16_bf16 v[64:79], v[40:43], v[36:39], v[64:79]
    ds_read_b128 v[20:23], v14
    ds_read_b64_tr_b16 v[24:25], v16 offset:4096
    s_waitcnt lgkmcnt(4)
    v_mfma_f32_32x32x16_bf16 v[80:95], v[44:47], v[36:39], v[80:95]
    ds_read_b64_tr_b16 v[26:27], v16 offset:4608
    ds_read_b64_tr_b16 v[28:29], v16 offset:12288
    s_waitcnt lgkmcnt(4)
    v_mfma_f32_32x32x16_bf16 v[96:111], v[36:39], v[48:51], v[96:111]
    ds_read_b64_tr_b16 v[30:31], v16 offset:12800
    ds_read_b64_tr_b16 v[32:33], v16 offset:20480
    ds_read_b64_tr_b16 v[34:35], v16 offset:20992
    s_waitcnt lgkmcnt(4)
    v_mfma_f32_32x32x16_bf16 v[64:79], v[24:27], v[20:23], v[64:79]
    ds_read_b128 v[36:39], v15
    ds_read_b64_tr_b16 v[40:41], v16 offset:6144
    s_waitcnt lgkmcnt(4)
    v_mfma_f32_32x32x16_bf16 v[80:95], v[28:31], v[20:23], v[80:95]
    ds_read_b64_tr_b16 v[42:43], v16 offset:6656
    ds_read_b64_tr_b16 v[44:45], v16 offset:14336
    s_waitcnt lgkmcnt(4)
    v_mfma_f32_32x32x16_bf16 v[96:111], v[20:23], v[32:35], v[96:111]
    ds_read_b64_tr_b16 v[46:47], v16 offset:14848
    ds_read_b64_tr_b16 v[48:49], v16 offset:22528
    ds_read_b64_tr_b16 v[50:51], v16 offset:23040
    s_waitcnt lgkmcnt(4)
    v_mfma_f32_32x32x16_bf16 v[64:79], v[40:43], v[36:39], v[64:79]
    s_waitcnt lgkmcnt(2)
    v_mfma_f32_32x32x16_bf16 v[80:95], v[44:47], v[36:39], v[80:95]
    s_waitcnt lgkmcnt(0)
    s_barrier
    v_add_u32 v12, 32768, v12
    v_add_u32 v13, 32768, v13
    v_add_u32 v14, 32768, v14
    v_add_u32 v15, 32768, v15
    v_add_u32 v16, 32768, v16
    ds_read_b128 v[20:23], v12
    ds_read_b64_tr_b16 v[24:25], v16 offset:0
    ds_read_b64_tr_b16 v[26:27], v16 offset:512
    v_mfma_f32_32x32x16_bf16 v[96:111], v[36:39], v[48:51], v[96:111]
    ds_read_b64_tr_b16 v[28:29], v16 offset:8192
    ds_read_b64_tr_b16 v[30:31], v16 offset:8704
    ds_read_b64_tr_b16 v[32:33], v16 offset:16384
    ds_read_b64_tr_b16 v[34:35], v16 offset:16896
    s_waitcnt lgkmcnt(4)
    v_mfma_f32_32x32x16_bf16 v[64:79], v[24:27], v[20:23], v[64:79]
    ds_read_b128 v[36:39], v13
    ds_read_b64_tr_b16 v[40:41], v16 offset:2048
    s_waitcnt lgkmcnt(4)
    v_mfma_f32_32x32x16_bf16 v[80:95], v[28:31], v[20:23], v[80:95]
    ds_read_b64_tr_b16 v[42:43], v16 offset:2560
    ds_read_b64_tr_b16 v[44:45], v16 offset:10240
    s_waitcnt lgkmcnt(4)
    v_mfma_f32_32x32x16_bf16 v[96:111], v[20:23], v[32:35], v[96:111]
    ds_read_b64_tr_b16 v[46:47], v16 offset:10752
    ds_read_b64_tr_b16 v[48:49], v16 offset:18432
    ds_read_b64_tr_b16 v[50:51], v16 offset:18944
    s_waitcnt lgkmcnt(4)
    v_mfma_f32_32x32x16_bf16 v[64:79], v[40:43], v[36:39], v[64:79]
    ds_read_b128 v[20:23], v14
    ds_read_b64_tr_b16 v[24:25], v16 offset:4096
    s_waitcnt lgkmcnt(4)
    v_mfma_f32_32x32x16_bf16 v[80:95], v[44:47], v[36:39], v[80:95]
    ds_read_b64_tr_b16 v[26:27], v16 offset:4608
    ds_read_b64_tr_b16 v[28:29], v16 offset:12288
    s_waitcnt lgkmcnt(4)
    v_mfma_f32_32x32x16_bf16 v[96:111], v[36:39], v[48:51], v[96:111]
    ds_read_b64_tr_b16 v[30:31], v16 offset:12800
    ds_read_b64_tr_b16 v[32:33], v16 offset:20480
    ds_read_b64_tr_b16 v[34:35], v16 offset:20992
    s_waitcnt lgkmcnt(4)
    v_mfma_f32_32x32x16_bf16 v[64:79], v[24:27], v[20:23], v[64:79]
    ds_read_b128 v[36:39], v15
    ds_read_b64_tr_b16 v[40:41], v16 offset:6144
    s_waitcnt lgkmcnt(4)
    v_mfma_f32_32x32x16_bf16 v[80:95], v[28:31], v[20:23], v[80:95]
    ds_read_b64_tr_b16 v[42:43], v16 offset:6656
    ds_read_b64_tr_b16 v[44:45], v16 offset:14336
    s_waitcnt lgkmcnt(4)
    v_mfma_f32_32x32x16_bf16 v[96:111], v[20:23], v[32:35], v[96:111]
    ds_read_b64_tr_b16 v[46:47], v16 offset:14848
    ds_read_b64_tr_b16 v[48:49], v16 offset:22528
    ds_read_b64_tr_b16 v[50:51], v16 offset:23040
    s_waitcnt lgkmcnt(4)
    v_mfma_f32_32x32x16_bf16 v[64:79], v[40:43], v[36:39], v[64:79]
    s_waitcnt lgkmcnt(2)
    v_mfma_f32_32x32x16_bf16 v[80:95], v[44:47], v[36:39], v[80:95]
    s_waitcnt lgkmcnt(0)
    s_barrier
    v_add_u32 v12, 32768, v12
    v_add_u32 v13, 32768, v13
    v_add_u32 v14, 32768, v14
    v_add_u32 v15, 32768, v15
    v_add_u32 v16, 32768, v16
    ds_read_b128 v[20:23], v12
    ds_read_b64_tr_b16 v[24:25], v16 offset:0
    ds_read_b64_tr_b16 v[26:27], v16 offset:512
    v_mfma_f32_32x32x16_bf16 v[96:111], v[36:39], v[48:51], v[96:111]
    ds_read_b64_tr_b16 v[28:29], v16 offset:8192
    ds_read_b64_tr_b16 v[30:31], v16 offset:8704
    ds_read_b64_tr_b16 v[32:33], v16 offset:16384
    ds_read_b64_tr_b16 v[34:35], v16 offset:16896
    s_waitcnt lgkmcnt(4)
    v_mfma_f32_32x32x16_bf16 v[64:79], v[24:27], v[20:23], v[64:79]
    ds_read_b128 v[36:39], v13
    ds_read_b64_tr_b16 v[40:41], v16 offset:2048
    s_waitcnt lgkmcnt(4)
    v_mfma_f32_32x32x16_bf16 v[80:95], v[28:31], v[20:23], v[80:95]
    ds_read_b64_tr_b16 v[42:43], v16 offset:2560
    ds_read_b64_tr_b16 v[44:45], v16 offset:10240
    s_waitcnt lgkmcnt(4)
    v_mfma_f32_32x32x16_bf16 v[96:111], v[20:23], v[32:35], v[96:111]
    ds_read_b64_tr_b16 v[46:47], v16 offset:10752
    ds_read_b64_tr_b16 v[48:49], v16 offset:18432
    ds_read_b64_tr_b16 v[50:51], v16 offset:18944
    s_waitcnt lgkmcnt(4)
    v_mfma_f32_32x32x16_bf16 v[64:79], v[40:43], v[36:39], v[64:79]
    ds_read_b128 v[20:23], v14
    ds_read_b64_tr_b16 v[24:25], v16 offset:4096
    s_waitcnt lgkmcnt(4)
    v_mfma_f32_32x32x16_bf16 v[80:95], v[44:47], v[36:39], v[80:95]
    ds_read_b64_tr_b16 v[26:27], v16 offset:4608
    ds_read_b64_tr_b16 v[28:29], v16 offset:12288
    s_waitcnt lgkmcnt(4)
    v_mfma_f32_32x32x16_bf16 v[96:111], v[36:39], v[48:51], v[96:111]
    ds_read_b64_tr_b16 v[30:31], v16 offset:12800
    ds_read_b64_tr_b16 v[32:33], v16 offset:20480
    ds_read_b64_tr_b16 v[34:35], v16 offset:20992
    s_waitcnt lgkmcnt(4)
    v_mfma_f32_32x32x16_bf16 v[64:79], v[24:27], v[20:23], v[64:79]
    ds_read_b128 v[36:39], v15
    ds_read_b64_tr_b16 v[40:41], v16 offset:6144
    s_waitcnt lgkmcnt(4)
    v_mfma_f32_32x32x16_bf16 v[80:95], v[28:31], v[20:23], v[80:95]
    ds_read_b64_tr_b16 v[42:43], v16 offset:6656
    ds_read_b64_tr_b16 v[44:45], v16 offset:14336
    s_waitcnt lgkmcnt(4)
    v_mfma_f32_32x32x16_bf16 v[96:111], v[20:23], v[32:35], v[96:111]
    ds_read_b64_tr_b16 v[46:47], v16 offset:14848
    ds_read_b64_tr_b16 v[48:49], v16 offset:22528
    ds_read_b64_tr_b16 v[50:51], v16 offset:23040
    s_waitcnt lgkmcnt(4)
    v_mfma_f32_32x32x16_bf16 v[64:79], v[40:43], v[36:39], v[64:79]
    s_waitcnt lgkmcnt(2)
    v_mfma_f32_32x32x16_bf16 v[80:95], v[44:47], v[36:39], v[80:95]
    s_waitcnt lgkmcnt(0)
    s_barrier
    v_mov_b32 v2, 0
    buffer_load_dword v3, v2, s[28:31], 0 offen offset:0 sc0 sc1
    v_add_u32 v12, -65536, v12
    v_add_u32 v13, -65536, v13
    v_add_u32 v14, -65536, v14
    v_add_u32 v15, -65536, v15
    v_add_u32 v16, -65536, v16
    ds_read_b128 v[20:23], v12
    ds_read_b64_tr_b16 v[24:25], v16 offset:0
    ds_read_b64_tr_b16 v[26:27], v16 offset:512
    v_mfma_f32_32x32x16_bf16 v[96:111], v[36:39], v[48:51], v[96:111]
    ds_read_b64_tr_b16 v[28:29], v16 offset:8192
    ds_read_b64_tr_b16 v[30:31], v16 offset:8704
    ds_read_b64_tr_b16 v[32:33], v16 offset:16384
    ds_read_b64_tr_b16 v[34:35], v16 offset:16896
    s_waitcnt lgkmcnt(4)
    v_mfma_f32_32x32x16_bf16 v[64:79], v[24:27], v[20:23], v[64:79]
    ds_read_b128 v[36:39], v13
    ds_read_b64_tr_b16 v[40:41], v16 offset:2048
    s_waitcnt lgkmcnt(4)
    v_mfma_f32_32x32x16_bf16 v[80:95], v[28:31], v[20:23], v[80:95]
    ds_read_b64_tr_b16 v[42:43], v16 offset:2560
    ds_read_b64_tr_b16 v[44:45], v16 offset:10240
    s_waitcnt lgkmcnt(4)
    v_mfma_f32_32x32x16_bf16 v[96:111], v[20:23], v[32:35], v[96:111]
    ds_read_b64_tr_b16 v[46:47], v16 offset:10752
    ds_read_b64_tr_b16 v[48:49], v16 offset:18432
    ds_read_b64_tr_b16 v[50:51], v16 offset:18944
    s_waitcnt lgkmcnt(4)
    v_mfma_f32_32x32x16_bf16 v[64:79], v[40:43], v[36:39], v[64:79]
    ds_read_b128 v[20:23], v14
    ds_read_b64_tr_b16 v[24:25], v16 offset:4096
    s_waitcnt lgkmcnt(4)
    v_mfma_f32_32x32x16_bf16 v[80:95], v[44:47], v[36:39], v[80:95]
    ds_read_b64_tr_b16 v[26:27], v16 offset:4608
    ds_read_b64_tr_b16 v[28:29], v16 offset:12288
    s_waitcnt lgkmcnt(4)
    v_mfma_f32_32x32x16_bf16 v[96:111], v[36:39], v[48:51], v[96:111]
    ds_read_b64_tr_b16 v[30:31], v16 offset:12800
    ds_read_b64_tr_b16 v[32:33], v16 offset:20480
    ds_read_b64_tr_b16 v[34:35], v16 offset:20992
    s_waitcnt lgkmcnt(4)
    v_mfma_f32_32x32x16_bf16 v[64:79], v[24:27], v[20:23], v[64:79]
    ds_read_b128 v[36:39], v15
    ds_read_b64_tr_b16 v[40:41], v16 offset:6144
    s_waitcnt lgkmcnt(4)
    v_mfma_f32_32x32x16_bf16 v[80:95], v[28:31], v[20:23], v[80:95]
    ds_read_b64_tr_b16 v[42:43], v16 offset:6656
    ds_read_b64_tr_b16 v[44:45], v16 offset:14336
    s_waitcnt lgkmcnt(4)
    v_mfma_f32_32x32x16_bf16 v[96:111], v[20:23], v[32:35], v[96:111]
    ds_read_b64_tr_b16 v[46:47], v16 offset:14848
    ds_read_b64_tr_b16 v[48:49], v16 offset:22528
    ds_read_b64_tr_b16 v[50:51], v16 offset:23040
    s_waitcnt lgkmcnt(4)
    v_mfma_f32_32x32x16_bf16 v[64:79], v[40:43], v[36:39], v[64:79]
    s_waitcnt lgkmcnt(2)
    v_mfma_f32_32x32x16_bf16 v[80:95], v[44:47], v[36:39], v[80:95]
    s_waitcnt lgkmcnt(0)
    s_barrier
    v_add_u32 v12, 32768, v12
    v_add_u32 v13, 32768, v13
    v_add_u32 v14, 32768, v14
    v_add_u32 v15, 32768, v15
    v_add_u32 v16, 32768, v16
    ds_read_b128 v[20:23], v12
    ds_read_b64_tr_b16 v[24:25], v16 offset:0
    ds_read_b64_tr_b16 v[26:27], v16 offset:512
    v_mfma_f32_32x32x16_bf16 v[96:111], v[36:39], v[48:51], v[96:111]
    ds_read_b64_tr_b16 v[28:29], v16 offset:8192
    ds_read_b64_tr_b16 v[30:31], v16 offset:8704
    ds_read_b64_tr_b16 v[32:33], v16 offset:16384
    ds_read_b64_tr_b16 v[34:35], v16 offset:16896
    s_waitcnt lgkmcnt(4)
    v_mfma_f32_32x32x16_bf16 v[64:79], v[24:27], v[20:23], v[64:79]
    ds_read_b128 v[36:39], v13
    ds_read_b64_tr_b16 v[40:41], v16 offset:2048
    s_waitcnt lgkmcnt(4)
    v_mfma_f32_32x32x16_bf16 v[80:95], v[28:31], v[20:23], v[80:95]
    ds_read_b64_tr_b16 v[42:43], v16 offset:2560
    ds_read_b64_tr_b16 v[44:45], v16 offset:10240
    s_waitcnt lgkmcnt(4)
    v_mfma_f32_32x32x16_bf16 v[96:111], v[20:23], v[32:35], v[96:111]
    ds_read_b64_tr_b16 v[46:47], v16 offset:10752
    ds_read_b64_tr_b16 v[48:49], v16 offset:18432
    ds_read_b64_tr_b16 v[50:51], v16 offset:18944
    s_waitcnt lgkmcnt(4)
    v_mfma_f32_32x32x16_bf16 v[64:79], v[40:43], v[36:39], v[64:79]
    ds_read_b128 v[20:23], v14
    ds_read_b64_tr_b16 v[24:25], v16 offset:4096
    s_waitcnt lgkmcnt(4)
    v_mfma_f32_32x32x16_bf16 v[80:95], v[44:47], v[36:39], v[80:95]
    ds_read_b64_tr_b16 v[26:27], v16 offset:4608
    ds_read_b64_tr_b16 v[28:29], v16 offset:12288
    s_waitcnt lgkmcnt(4)
    v_mfma_f32_32x32x16_bf16 v[96:111], v[36:39], v[48:51], v[96:111]
    ds_read_b64_tr_b16 v[30:31], v16 offset:12800
    ds_read_b64_tr_b16 v[32:33], v16 offset:20480
    ds_read_b64_tr_b16 v[34:35], v16 offset:20992
    s_waitcnt lgkmcnt(4)
    v_mfma_f32_32x32x16_bf16 v[64:79], v[24:27], v[20:23], v[64:79]
    ds_read_b128 v[36:39], v15
    ds_read_b64_tr_b16 v[40:41], v16 offset:6144
    s_waitcnt lgkmcnt(4)
    v_mfma_f32_32x32x16_bf16 v[80:95], v[28:31], v[20:23], v[80:95]
    ds_read_b64_tr_b16 v[42:43], v16 offset:6656
    ds_read_b64_tr_b16 v[44:45], v16 offset:14336
    s_waitcnt lgkmcnt(4)
    v_mfma_f32_32x32x16_bf16 v[96:111], v[20:23], v[32:35], v[96:111]
    ds_read_b64_tr_b16 v[46:47], v16 offset:14848
    ds_read_b64_tr_b16 v[48:49], v16 offset:22528
    ds_read_b64_tr_b16 v[50:51], v16 offset:23040
    s_waitcnt lgkmcnt(4)
    v_mfma_f32_32x32x16_bf16 v[64:79], v[40:43], v[36:39], v[64:79]
    s_waitcnt lgkmcnt(2)
    v_mfma_f32_32x32x16_bf16 v[80:95], v[44:47], v[36:39], v[80:95]
    s_waitcnt lgkmcnt(0)
    s_barrier
    s_lshl_b32 s21, s61, 7
    s_lshl_b32 s22, s60, 2
    s_add_u32 s21, s21, s22
    s_add_u32 s63, s21, 18874368
    s_mov_b32 s3, 0

    v_add_u32 v12, 32768, v12
    v_add_u32 v13, 32768, v13
    v_add_u32 v14, 32768, v14
    v_add_u32 v15, 32768, v15
    v_add_u32 v16, 32768, v16
    ds_read_b128 v[20:23], v12
    ds_read_b64_tr_b16 v[24:25], v16 offset:0
    ds_read_b64_tr_b16 v[26:27], v16 offset:512
    v_mfma_f32_32x32x16_bf16 v[96:111], v[36:39], v[48:51], v[96:111]
    ds_read_b64_tr_b16 v[28:29], v16 offset:8192
    ds_read_b64_tr_b16 v[30:31], v16 offset:8704
    ds_read_b64_tr_b16 v[32:33], v16 offset:16384
    ds_read_b64_tr_b16 v[34:35], v16 offset:16896
    s_waitcnt lgkmcnt(4)
    v_mfma_f32_32x32x16_bf16 v[136:151], v[24:27], v[20:23], 0
    ds_read_b128 v[36:39], v13
    ds_read_b64_tr_b16 v[40:41], v16 offset:2048
    s_waitcnt lgkmcnt(4)
    v_mfma_f32_32x32x16_bf16 v[152:167], v[28:31], v[20:23], 0
    ds_read_b64_tr_b16 v[42:43], v16 offset:2560
    ds_read_b64_tr_b16 v[44:45], v16 offset:10240
    s_waitcnt lgkmcnt(4)
    v_mfma_f32_32x32x16_bf16 v[168:183], v[20:23], v[32:35], 0
    ds_read_b64_tr_b16 v[46:47], v16 offset:10752
    ds_read_b64_tr_b16 v[48:49], v16 offset:18432
    ds_read_b64_tr_b16 v[50:51], v16 offset:18944
    s_waitcnt lgkmcnt(4)
    v_mfma_f32_32x32x16_bf16 v[136:151], v[40:43], v[36:39], v[136:151]
    ds_read_b128 v[20:23], v14
    ds_read_b64_tr_b16 v[24:25], v16 offset:4096
    v_cvt_pk_bf16_f32 v120, v80, v81
    v_cvt_pk_bf16_f32 v121, v82, v83
    v_cvt_pk_bf16_f32 v122, v84, v85
    v_cvt_pk_bf16_f32 v123, v86, v87
    v_cvt_pk_bf16_f32 v124, v88, v89
    v_cvt_pk_bf16_f32 v125, v90, v91
    v_cvt_pk_bf16_f32 v126, v92, v93
    v_cvt_pk_bf16_f32 v127, v94, v95
    s_add_u32 s21, s62, 2097152
    buffer_store_dwordx4 v[120:123], v17, s[16:19], s21 offen sc0 sc1
    s_add_u32 s21, s62, 2162688
    buffer_store_dwordx4 v[124:127], v17, s[16:19], s21 offen sc0 sc1
    v_cvt_pk_bf16_f32 v128, v96, v97
    v_cvt_pk_bf16_f32 v129, v98, v99
    v_cvt_pk_bf16_f32 v130, v100, v101
    v_cvt_pk_bf16_f32 v131, v102, v103
    v_cvt_pk_bf16_f32 v132, v104, v105
    v_cvt_pk_bf16_f32 v133, v106, v107
    v_cvt_pk_bf16_f32 v134, v108, v109
    v_cvt_pk_bf16_f32 v135, v110, v111
    s_add_u32 s21, s62, 4194304
    buffer_store_dwordx4 v[128:131], v18, s[16:19], s21 offen sc0 sc1
    buffer_store_dwordx4 v[132:135], v18, s[16:19], s21 offen offset:512 sc0 sc1
    v_mul_f32 v64, s27, v64
    v_mul_f32 v65, s27, v65
    v_mul_f32 v66, s27, v66
    v_mul_f32 v67, s27, v67
    s_waitcnt lgkmcnt(4)
    v_mfma_f32_32x32x16_bf16 v[152:167], v[44:47], v[36:39], v[152:167]
    ds_read_b64_tr_b16 v[26:27], v16 offset:4608
    ds_read_b64_tr_b16 v[28:29], v16 offset:12288
    v_mul_f32 v68, s27, v68
    v_mul_f32 v69, s27, v69
    v_mul_f32 v70, s27, v70
    v_mul_f32 v71, s27, v71
    v_mul_f32 v72, s27, v72
    v_mul_f32 v73, s27, v73
    v_mul_f32 v74, s27, v74
    v_mul_f32 v75, s27, v75
    v_mul_f32 v76, s27, v76
    v_mul_f32 v77, s27, v77
    v_mul_f32 v78, s27, v78
    v_mul_f32 v79, s27, v79
    v_cvt_pk_bf16_f32 v112, v64, v65
    v_cvt_pk_bf16_f32 v113, v66, v67
    v_cvt_pk_bf16_f32 v114, v68, v69
    v_cvt_pk_bf16_f32 v115, v70, v71
    v_cvt_pk_bf16_f32 v116, v72, v73
    v_cvt_pk_bf16_f32 v117, v74, v75
    v_cvt_pk_bf16_f32 v118, v76, v77
    v_cvt_pk_bf16_f32 v119, v78, v79
    s_add_u32 s21, s62, 0
    buffer_store_dwordx4 v[112:115], v1, s[16:19], s21 offen sc0 sc1
    s_add_u32 s21, s62, 65536
    buffer_store_dwordx4 v[116:119], v1, s[16:19], s21 offen sc0 sc1
    s_waitcnt lgkmcnt(4)
    v_mfma_f32_32x32x16_bf16 v[168:183], v[36:39], v[48:51], v[168:183]
    ds_read_b64_tr_b16 v[30:31], v16 offset:12800
    ds_read_b64_tr_b16 v[32:33], v16 offset:20480
    ds_read_b64_tr_b16 v[34:35], v16 offset:20992
    s_waitcnt lgkmcnt(4)
    v_mfma_f32_32x32x16_bf16 v[136:151], v[24:27], v[20:23], v[136:151]
    ds_read_b128 v[36:39], v15
    ds_read_b64_tr_b16 v[40:41], v16 offset:6144
    s_waitcnt lgkmcnt(4)
    v_mfma_f32_32x32x16_bf16 v[152:167], v[28:31], v[20:23], v[152:167]
    ds_read_b64_tr_b16 v[42:43], v16 offset:6656
    ds_read_b64_tr_b16 v[44:45], v16 offset:14336
    s_waitcnt lgkmcnt(4)
    v_mfma_f32_32x32x16_bf16 v[168:183], v[20:23], v[32:35], v[168:183]
    ds_read_b64_tr_b16 v[46:47], v16 offset:14848
    ds_read_b64_tr_b16 v[48:49], v16 offset:22528
    ds_read_b64_tr_b16 v[50:51], v16 offset:23040
    s_waitcnt lgkmcnt(4)
    v_mfma_f32_32x32x16_bf16 v[136:151], v[40:43], v[36:39], v[136:151]
    s_waitcnt lgkmcnt(2)
    v_mfma_f32_32x32x16_bf16 v[152:167], v[44:47], v[36:39], v[152:167]
    s_waitcnt lgkmcnt(0)
    s_barrier
    v_add_u32 v12, -65536, v12
    v_add_u32 v13, -65536, v13
    v_add_u32 v14, -65536, v14
    v_add_u32 v15, -65536, v15
    v_add_u32 v16, -65536, v16
    ds_read_b128 v[20:23], v12
    ds_read_b64_tr_b16 v[24:25], v16 offset:0
    ds_read_b64_tr_b16 v[26:27], v16 offset:512
    v_mfma_f32_32x32x16_bf16 v[168:183], v[36:39], v[48:51], v[168:183]
    ds_read_b64_tr_b16 v[28:29], v16 offset:8192
    ds_read_b64_tr_b16 v[30:31], v16 offset:8704
    ds_read_b64_tr_b16 v[32:33], v16 offset:16384
    ds_read_b64_tr_b16 v[34:35], v16 offset:16896
    s_waitcnt lgkmcnt(4)
    v_mfma_f32_32x32x16_bf16 v[136:151], v[24:27], v[20:23], v[136:151]
    ds_read_b128 v[36:39], v13
    ds_read_b64_tr_b16 v[40:41], v16 offset:2048
    s_waitcnt lgkmcnt(4)
    v_mfma_f32_32x32x16_bf16 v[152:167], v[28:31], v[20:23], v[152:167]
    ds_read_b64_tr_b16 v[42:43], v16 offset:2560
    ds_read_b64_tr_b16 v[44:45], v16 offset:10240
    s_waitcnt lgkmcnt(4)
    v_mfma_f32_32x32x16_bf16 v[168:183], v[20:23], v[32:35], v[168:183]
    ds_read_b64_tr_b16 v[46:47], v16 offset:10752
    ds_read_b64_tr_b16 v[48:49], v16 offset:18432
    ds_read_b64_tr_b16 v[50:51], v16 offset:18944
    s_waitcnt lgkmcnt(4)
    v_mfma_f32_32x32x16_bf16 v[136:151], v[40:43], v[36:39], v[136:151]
    ds_read_b128 v[20:23], v14
    ds_read_b64_tr_b16 v[24:25], v16 offset:4096
    s_waitcnt lgkmcnt(4)
    v_mfma_f32_32x32x16_bf16 v[152:167], v[44:47], v[36:39], v[152:167]
    ds_read_b64_tr_b16 v[26:27], v16 offset:4608
    ds_read_b64_tr_b16 v[28:29], v16 offset:12288
    s_waitcnt lgkmcnt(4)
    v_mfma_f32_32x32x16_bf16 v[168:183], v[36:39], v[48:51], v[168:183]
    ds_read_b64_tr_b16 v[30:31], v16 offset:12800
    ds_read_b64_tr_b16 v[32:33], v16 offset:20480
    ds_read_b64_tr_b16 v[34:35], v16 offset:20992
    s_waitcnt lgkmcnt(4)
    v_mfma_f32_32x32x16_bf16 v[136:151], v[24:27], v[20:23], v[136:151]
    ds_read_b128 v[36:39], v15
    ds_read_b64_tr_b16 v[40:41], v16 offset:6144
    s_waitcnt lgkmcnt(4)
    v_mfma_f32_32x32x16_bf16 v[152:167], v[28:31], v[20:23], v[152:167]
    ds_read_b64_tr_b16 v[42:43], v16 offset:6656
    ds_read_b64_tr_b16 v[44:45], v16 offset:14336
    s_waitcnt lgkmcnt(4)
    v_mfma_f32_32x32x16_bf16 v[168:183], v[20:23], v[32:35], v[168:183]
    ds_read_b64_tr_b16 v[46:47], v16 offset:14848
    ds_read_b64_tr_b16 v[48:49], v16 offset:22528
    ds_read_b64_tr_b16 v[50:51], v16 offset:23040
    s_waitcnt lgkmcnt(4)
    v_mfma_f32_32x32x16_bf16 v[136:151], v[40:43], v[36:39], v[136:151]
    s_waitcnt lgkmcnt(2)
    v_mfma_f32_32x32x16_bf16 v[152:167], v[44:47], v[36:39], v[152:167]
    s_waitcnt lgkmcnt(0)
    s_barrier
    s_cmp_eq_u32 s3, 1
    s_cbranch_scc1 PUB_1
    s_waitcnt vmcnt(0)
    s_mov_b32 s56, 0
NN_2:
    v_readfirstlane_b32 s46, v3
    s_cmp_lg_u32 s46, 0
    s_cbranch_scc1 NNE_3
    s_add_u32 s56, s56, 1
    s_cmp_gt_u32 s56, 200000
    s_cbranch_scc1 NNE_3
    buffer_load_dword v3, v2, s[28:31], 0 offen offset:0 sc0 sc1
    s_waitcnt vmcnt(0)
    s_branch NN_2
NNE_3:

    v_mov_b32 v4, s46
    v_mov_b32 v5, 0
    s_mov_b64 exec, 1
    buffer_store_dword v4, v5, s[16:19], s63 offen sc0 sc1
    s_mov_b64 exec, -1

    s_mov_b32 s3, 1
PUB_1:
    v_add_u32 v12, 32768, v12
    v_add_u32 v13, 32768, v13
    v_add_u32 v14, 32768, v14
    v_add_u32 v15, 32768, v15
    v_add_u32 v16, 32768, v16
    ds_read_b128 v[20:23], v12
    ds_read_b64_tr_b16 v[24:25], v16 offset:0
    ds_read_b64_tr_b16 v[26:27], v16 offset:512
    v_mfma_f32_32x32x16_bf16 v[168:183], v[36:39], v[48:51], v[168:183]
    ds_read_b64_tr_b16 v[28:29], v16 offset:8192
    ds_read_b64_tr_b16 v[30:31], v16 offset:8704
    ds_read_b64_tr_b16 v[32:33], v16 offset:16384
    ds_read_b64_tr_b16 v[34:35], v16 offset:16896
    s_waitcnt lgkmcnt(4)
    v_mfma_f32_32x32x16_bf16 v[136:151], v[24:27], v[20:23], v[136:151]
    ds_read_b128 v[36:39], v13
    ds_read_b64_tr_b16 v[40:41], v16 offset:2048
    s_waitcnt lgkmcnt(4)
    v_mfma_f32_32x32x16_bf16 v[152:167], v[28:31], v[20:23], v[152:167]
    ds_read_b64_tr_b16 v[42:43], v16 offset:2560
    ds_read_b64_tr_b16 v[44:45], v16 offset:10240
    s_waitcnt lgkmcnt(4)
    v_mfma_f32_32x32x16_bf16 v[168:183], v[20:23], v[32:35], v[168:183]
    ds_read_b64_tr_b16 v[46:47], v16 offset:10752
    ds_read_b64_tr_b16 v[48:49], v16 offset:18432
    ds_read_b64_tr_b16 v[50:51], v16 offset:18944
    s_waitcnt lgkmcnt(4)
    v_mfma_f32_32x32x16_bf16 v[136:151], v[40:43], v[36:39], v[136:151]
    ds_read_b128 v[20:23], v14
    ds_read_b64_tr_b16 v[24:25], v16 offset:4096
    s_waitcnt lgkmcnt(4)
    v_mfma_f32_32x32x16_bf16 v[152:167], v[44:47], v[36:39], v[152:167]
    ds_read_b64_tr_b16 v[26:27], v16 offset:4608
    ds_read_b64_tr_b16 v[28:29], v16 offset:12288
    s_waitcnt lgkmcnt(4)
    v_mfma_f32_32x32x16_bf16 v[168:183], v[36:39], v[48:51], v[168:183]
    ds_read_b64_tr_b16 v[30:31], v16 offset:12800
    ds_read_b64_tr_b16 v[32:33], v16 offset:20480
    ds_read_b64_tr_b16 v[34:35], v16 offset:20992
    s_waitcnt lgkmcnt(4)
    v_mfma_f32_32x32x16_bf16 v[136:151], v[24:27], v[20:23], v[136:151]
    ds_read_b128 v[36:39], v15
    ds_read_b64_tr_b16 v[40:41], v16 offset:6144
    s_waitcnt lgkmcnt(4)
    v_mfma_f32_32x32x16_bf16 v[152:167], v[28:31], v[20:23], v[152:167]
    ds_read_b64_tr_b16 v[42:43], v16 offset:6656
    ds_read_b64_tr_b16 v[44:45], v16 offset:14336
    s_waitcnt lgkmcnt(4)
    v_mfma_f32_32x32x16_bf16 v[168:183], v[20:23], v[32:35], v[168:183]
    ds_read_b64_tr_b16 v[46:47], v16 offset:14848
    ds_read_b64_tr_b16 v[48:49], v16 offset:22528
    ds_read_b64_tr_b16 v[50:51], v16 offset:23040
    s_waitcnt lgkmcnt(4)
    v_mfma_f32_32x32x16_bf16 v[136:151], v[40:43], v[36:39], v[136:151]
    s_waitcnt lgkmcnt(2)
    v_mfma_f32_32x32x16_bf16 v[152:167], v[44:47], v[36:39], v[152:167]
    s_waitcnt lgkmcnt(0)
    s_barrier
    v_add_u32 v12, 32768, v12
    v_add_u32 v13, 32768, v13
    v_add_u32 v14, 32768, v14
    v_add_u32 v15, 32768, v15
    v_add_u32 v16, 32768, v16
    ds_read_b128 v[20:23], v12
    ds_read_b64_tr_b16 v[24:25], v16 offset:0
    ds_read_b64_tr_b16 v[26:27], v16 offset:512
    v_mfma_f32_32x32x16_bf16 v[168:183], v[36:39], v[48:51], v[168:183]
    ds_read_b64_tr_b16 v[28:29], v16 offset:8192
    ds_read_b64_tr_b16 v[30:31], v16 offset:8704
    ds_read_b64_tr_b16 v[32:33], v16 offset:16384
    ds_read_b64_tr_b16 v[34:35], v16 offset:16896
    s_waitcnt lgkmcnt(4)
    v_mfma_f32_32x32x16_bf16 v[136:151], v[24:27], v[20:23], v[136:151]
    ds_read_b128 v[36:39], v13
    ds_read_b64_tr_b16 v[40:41], v16 offset:2048
    s_waitcnt lgkmcnt(4)
    v_mfma_f32_32x32x16_bf16 v[152:167], v[28:31], v[20:23], v[152:167]
    ds_read_b64_tr_b16 v[42:43], v16 offset:2560
    ds_read_b64_tr_b16 v[44:45], v16 offset:10240
    s_waitcnt lgkmcnt(4)
    v_mfma_f32_32x32x16_bf16 v[168:183], v[20:23], v[32:35], v[168:183]
    ds_read_b64_tr_b16 v[46:47], v16 offset:10752
    ds_read_b64_tr_b16 v[48:49], v16 offset:18432
    ds_read_b64_tr_b16 v[50:51], v16 offset:18944
    s_waitcnt lgkmcnt(4)
    v_mfma_f32_32x32x16_bf16 v[136:151], v[40:43], v[36:39], v[136:151]
    ds_read_b128 v[20:23], v14
    ds_read_b64_tr_b16 v[24:25], v16 offset:4096
    s_waitcnt lgkmcnt(4)
    v_mfma_f32_32x32x16_bf16 v[152:167], v[44:47], v[36:39], v[152:167]
    ds_read_b64_tr_b16 v[26:27], v16 offset:4608
    ds_read_b64_tr_b16 v[28:29], v16 offset:12288
    s_waitcnt lgkmcnt(4)
    v_mfma_f32_32x32x16_bf16 v[168:183], v[36:39], v[48:51], v[168:183]
    ds_read_b64_tr_b16 v[30:31], v16 offset:12800
    ds_read_b64_tr_b16 v[32:33], v16 offset:20480
    ds_read_b64_tr_b16 v[34:35], v16 offset:20992
    s_waitcnt lgkmcnt(4)
    v_mfma_f32_32x32x16_bf16 v[136:151], v[24:27], v[20:23], v[136:151]
    ds_read_b128 v[36:39], v15
    ds_read_b64_tr_b16 v[40:41], v16 offset:6144
    s_waitcnt lgkmcnt(4)
    v_mfma_f32_32x32x16_bf16 v[152:167], v[28:31], v[20:23], v[152:167]
    ds_read_b64_tr_b16 v[42:43], v16 offset:6656
    ds_read_b64_tr_b16 v[44:45], v16 offset:14336
    s_waitcnt lgkmcnt(4)
    v_mfma_f32_32x32x16_bf16 v[168:183], v[20:23], v[32:35], v[168:183]
    ds_read_b64_tr_b16 v[46:47], v16 offset:14848
    ds_read_b64_tr_b16 v[48:49], v16 offset:22528
    ds_read_b64_tr_b16 v[50:51], v16 offset:23040
    s_waitcnt lgkmcnt(4)
    v_mfma_f32_32x32x16_bf16 v[136:151], v[40:43], v[36:39], v[136:151]
    s_waitcnt lgkmcnt(2)
    v_mfma_f32_32x32x16_bf16 v[152:167], v[44:47], v[36:39], v[152:167]
    s_waitcnt lgkmcnt(0)
    s_barrier
    v_add_u32 v12, -65536, v12
    v_add_u32 v13, -65536, v13
    v_add_u32 v14, -65536, v14
    v_add_u32 v15, -65536, v15
    v_add_u32 v16, -65536, v16
    ds_read_b128 v[20:23], v12
    ds_read_b64_tr_b16 v[24:25], v16 offset:0
    ds_read_b64_tr_b16 v[26:27], v16 offset:512
    v_mfma_f32_32x32x16_bf16 v[168:183], v[36:39], v[48:51], v[168:183]
    ds_read_b64_tr_b16 v[28:29], v16 offset:8192
    ds_read_b64_tr_b16 v[30:31], v16 offset:8704
    ds_read_b64_tr_b16 v[32:33], v16 offset:16384
    ds_read_b64_tr_b16 v[34:35], v16 offset:16896
    s_waitcnt lgkmcnt(4)
    v_mfma_f32_32x32x16_bf16 v[136:151], v[24:27], v[20:23], v[136:151]
    ds_read_b128 v[36:39], v13
    ds_read_b64_tr_b16 v[40:41], v16 offset:2048
    s_waitcnt lgkmcnt(4)
    v_mfma_f32_32x32x16_bf16 v[152:167], v[28:31], v[20:23], v[152:167]
    ds_read_b64_tr_b16 v[42:43], v16 offset:2560
    ds_read_b64_tr_b16 v[44:45], v16 offset:10240
    s_waitcnt lgkmcnt(4)
    v_mfma_f32_32x32x16_bf16 v[168:183], v[20:23], v[32:35], v[168:183]
    ds_read_b64_tr_b16 v[46:47], v16 offset:10752
    ds_read_b64_tr_b16 v[48:49], v16 offset:18432
    ds_read_b64_tr_b16 v[50:51], v16 offset:18944
    s_waitcnt lgkmcnt(4)
    v_mfma_f32_32x32x16_bf16 v[136:151], v[40:43], v[36:39], v[136:151]
    ds_read_b128 v[20:23], v14
    ds_read_b64_tr_b16 v[24:25], v16 offset:4096
    s_waitcnt lgkmcnt(4)
    v_mfma_f32_32x32x16_bf16 v[152:167], v[44:47], v[36:39], v[152:167]
    ds_read_b64_tr_b16 v[26:27], v16 offset:4608
    ds_read_b64_tr_b16 v[28:29], v16 offset:12288
    s_waitcnt lgkmcnt(4)
    v_mfma_f32_32x32x16_bf16 v[168:183], v[36:39], v[48:51], v[168:183]
    ds_read_b64_tr_b16 v[30:31], v16 offset:12800
    ds_read_b64_tr_b16 v[32:33], v16 offset:20480
    ds_read_b64_tr_b16 v[34:35], v16 offset:20992
    s_waitcnt lgkmcnt(4)
    v_mfma_f32_32x32x16_bf16 v[136:151], v[24:27], v[20:23], v[136:151]
    ds_read_b128 v[36:39], v15
    ds_read_b64_tr_b16 v[40:41], v16 offset:6144
    s_waitcnt lgkmcnt(4)
    v_mfma_f32_32x32x16_bf16 v[152:167], v[28:31], v[20:23], v[152:167]
    ds_read_b64_tr_b16 v[42:43], v16 offset:6656
    ds_read_b64_tr_b16 v[44:45], v16 offset:14336
    s_waitcnt lgkmcnt(4)
    v_mfma_f32_32x32x16_bf16 v[168:183], v[20:23], v[32:35], v[168:183]
    ds_read_b64_tr_b16 v[46:47], v16 offset:14848
    ds_read_b64_tr_b16 v[48:49], v16 offset:22528
    ds_read_b64_tr_b16 v[50:51], v16 offset:23040
    s_waitcnt lgkmcnt(4)
    v_mfma_f32_32x32x16_bf16 v[136:151], v[40:43], v[36:39], v[136:151]
    s_waitcnt lgkmcnt(2)
    v_mfma_f32_32x32x16_bf16 v[152:167], v[44:47], v[36:39], v[152:167]
    s_waitcnt lgkmcnt(0)
    s_barrier
    v_add_u32 v12, 32768, v12
    v_add_u32 v13, 32768, v13
    v_add_u32 v14, 32768, v14
    v_add_u32 v15, 32768, v15
    v_add_u32 v16, 32768, v16
    ds_read_b128 v[20:23], v12
    ds_read_b64_tr_b16 v[24:25], v16 offset:0
    ds_read_b64_tr_b16 v[26:27], v16 offset:512
    v_mfma_f32_32x32x16_bf16 v[168:183], v[36:39], v[48:51], v[168:183]
    ds_read_b64_tr_b16 v[28:29], v16 offset:8192
    ds_read_b64_tr_b16 v[30:31], v16 offset:8704
    ds_read_b64_tr_b16 v[32:33], v16 offset:16384
    ds_read_b64_tr_b16 v[34:35], v16 offset:16896
    s_waitcnt lgkmcnt(4)
    v_mfma_f32_32x32x16_bf16 v[136:151], v[24:27], v[20:23], v[136:151]
    ds_read_b128 v[36:39], v13
    ds_read_b64_tr_b16 v[40:41], v16 offset:2048
    s_waitcnt lgkmcnt(4)
    v_mfma_f32_32x32x16_bf16 v[152:167], v[28:31], v[20:23], v[152:167]
    ds_read_b64_tr_b16 v[42:43], v16 offset:2560
    ds_read_b64_tr_b16 v[44:45], v16 offset:10240
    s_waitcnt lgkmcnt(4)
    v_mfma_f32_32x32x16_bf16 v[168:183], v[20:23], v[32:35], v[168:183]
    ds_read_b64_tr_b16 v[46:47], v16 offset:10752
    ds_read_b64_tr_b16 v[48:49], v16 offset:18432
    ds_read_b64_tr_b16 v[50:51], v16 offset:18944
    s_waitcnt lgkmcnt(4)
    v_mfma_f32_32x32x16_bf16 v[136:151], v[40:43], v[36:39], v[136:151]
    ds_read_b128 v[20:23], v14
    ds_read_b64_tr_b16 v[24:25], v16 offset:4096
    s_waitcnt lgkmcnt(4)
    v_mfma_f32_32x32x16_bf16 v[152:167], v[44:47], v[36:39], v[152:167]
    ds_read_b64_tr_b16 v[26:27], v16 offset:4608
    ds_read_b64_tr_b16 v[28:29], v16 offset:12288
    s_waitcnt lgkmcnt(4)
    v_mfma_f32_32x32x16_bf16 v[168:183], v[36:39], v[48:51], v[168:183]
    ds_read_b64_tr_b16 v[30:31], v16 offset:12800
    ds_read_b64_tr_b16 v[32:33], v16 offset:20480
    ds_read_b64_tr_b16 v[34:35], v16 offset:20992
    s_waitcnt lgkmcnt(4)
    v_mfma_f32_32x32x16_bf16 v[136:151], v[24:27], v[20:23], v[136:151]
    ds_read_b128 v[36:39], v15
    ds_read_b64_tr_b16 v[40:41], v16 offset:6144
    s_waitcnt lgkmcnt(4)
    v_mfma_f32_32x32x16_bf16 v[152:167], v[28:31], v[20:23], v[152:167]
    ds_read_b64_tr_b16 v[42:43], v16 offset:6656
    ds_read_b64_tr_b16 v[44:45], v16 offset:14336
    s_waitcnt lgkmcnt(4)
    v_mfma_f32_32x32x16_bf16 v[168:183], v[20:23], v[32:35], v[168:183]
    ds_read_b64_tr_b16 v[46:47], v16 offset:14848
    ds_read_b64_tr_b16 v[48:49], v16 offset:22528
    ds_read_b64_tr_b16 v[50:51], v16 offset:23040
    s_waitcnt lgkmcnt(4)
    v_mfma_f32_32x32x16_bf16 v[136:151], v[40:43], v[36:39], v[136:151]
    s_waitcnt lgkmcnt(2)
    v_mfma_f32_32x32x16_bf16 v[152:167], v[44:47], v[36:39], v[152:167]
    s_waitcnt lgkmcnt(0)
    s_barrier
    v_add_u32 v12, 32768, v12
    v_add_u32 v13, 32768, v13
    v_add_u32 v14, 32768, v14
    v_add_u32 v15, 32768, v15
    v_add_u32 v16, 32768, v16
    ds_read_b128 v[20:23], v12
    ds_read_b64_tr_b16 v[24:25], v16 offset:0
    ds_read_b64_tr_b16 v[26:27], v16 offset:512
    v_mfma_f32_32x32x16_bf16 v[168:183], v[36:39], v[48:51], v[168:183]
    ds_read_b64_tr_b16 v[28:29], v16 offset:8192
    ds_read_b64_tr_b16 v[30:31], v16 offset:8704
    ds_read_b64_tr_b16 v[32:33], v16 offset:16384
    ds_read_b64_tr_b16 v[34:35], v16 offset:16896
    s_waitcnt lgkmcnt(4)
    v_mfma_f32_32x32x16_bf16 v[136:151], v[24:27], v[20:23], v[136:151]
    ds_read_b128 v[36:39], v13
    ds_read_b64_tr_b16 v[40:41], v16 offset:2048
    s_waitcnt lgkmcnt(4)
    v_mfma_f32_32x32x16_bf16 v[152:167], v[28:31], v[20:23], v[152:167]
    ds_read_b64_tr_b16 v[42:43], v16 offset:2560
    ds_read_b64_tr_b16 v[44:45], v16 offset:10240
    s_waitcnt lgkmcnt(4)
    v_mfma_f32_32x32x16_bf16 v[168:183], v[20:23], v[32:35], v[168:183]
    ds_read_b64_tr_b16 v[46:47], v16 offset:10752
    ds_read_b64_tr_b16 v[48:49], v16 offset:18432
    ds_read_b64_tr_b16 v[50:51], v16 offset:18944
    s_waitcnt lgkmcnt(4)
    v_mfma_f32_32x32x16_bf16 v[136:151], v[40:43], v[36:39], v[136:151]
    ds_read_b128 v[20:23], v14
    ds_read_b64_tr_b16 v[24:25], v16 offset:4096
    s_waitcnt lgkmcnt(4)
    v_mfma_f32_32x32x16_bf16 v[152:167], v[44:47], v[36:39], v[152:167]
    ds_read_b64_tr_b16 v[26:27], v16 offset:4608
    ds_read_b64_tr_b16 v[28:29], v16 offset:12288
    s_waitcnt lgkmcnt(4)
    v_mfma_f32_32x32x16_bf16 v[168:183], v[36:39], v[48:51], v[168:183]
    ds_read_b64_tr_b16 v[30:31], v16 offset:12800
    ds_read_b64_tr_b16 v[32:33], v16 offset:20480
    ds_read_b64_tr_b16 v[34:35], v16 offset:20992
    s_waitcnt lgkmcnt(4)
    v_mfma_f32_32x32x16_bf16 v[136:151], v[24:27], v[20:23], v[136:151]
    ds_read_b128 v[36:39], v15
    ds_read_b64_tr_b16 v[40:41], v16 offset:6144
    s_waitcnt lgkmcnt(4)
    v_mfma_f32_32x32x16_bf16 v[152:167], v[28:31], v[20:23], v[152:167]
    ds_read_b64_tr_b16 v[42:43], v16 offset:6656
    ds_read_b64_tr_b16 v[44:45], v16 offset:14336
    s_waitcnt lgkmcnt(4)
    v_mfma_f32_32x32x16_bf16 v[168:183], v[20:23], v[32:35], v[168:183]
    ds_read_b64_tr_b16 v[46:47], v16 offset:14848
    ds_read_b64_tr_b16 v[48:49], v16 offset:22528
    ds_read_b64_tr_b16 v[50:51], v16 offset:23040
    s_waitcnt lgkmcnt(4)
    v_mfma_f32_32x32x16_bf16 v[136:151], v[40:43], v[36:39], v[136:151]
    s_waitcnt lgkmcnt(2)
    v_mfma_f32_32x32x16_bf16 v[152:167], v[44:47], v[36:39], v[152:167]
    s_waitcnt lgkmcnt(0)
    s_barrier
    v_add_u32 v12, -65536, v12
    v_add_u32 v13, -65536, v13
    v_add_u32 v14, -65536, v14
    v_add_u32 v15, -65536, v15
    v_add_u32 v16, -65536, v16
    ds_read_b128 v[20:23], v12
    ds_read_b64_tr_b16 v[24:25], v16 offset:0
    ds_read_b64_tr_b16 v[26:27], v16 offset:512
    v_mfma_f32_32x32x16_bf16 v[168:183], v[36:39], v[48:51], v[168:183]
    ds_read_b64_tr_b16 v[28:29], v16 offset:8192
    ds_read_b64_tr_b16 v[30:31], v16 offset:8704
    ds_read_b64_tr_b16 v[32:33], v16 offset:16384
    ds_read_b64_tr_b16 v[34:35], v16 offset:16896
    s_waitcnt lgkmcnt(4)
    v_mfma_f32_32x32x16_bf16 v[136:151], v[24:27], v[20:23], v[136:151]
    ds_read_b128 v[36:39], v13
    ds_read_b64_tr_b16 v[40:41], v16 offset:2048
    s_waitcnt lgkmcnt(4)
    v_mfma_f32_32x32x16_bf16 v[152:167], v[28:31], v[20:23], v[152:167]
    ds_read_b64_tr_b16 v[42:43], v16 offset:2560
    ds_read_b64_tr_b16 v[44:45], v16 offset:10240
    s_waitcnt lgkmcnt(4)
    v_mfma_f32_32x32x16_bf16 v[168:183], v[20:23], v[32:35], v[168:183]
    ds_read_b64_tr_b16 v[46:47], v16 offset:10752
    ds_read_b64_tr_b16 v[48:49], v16 offset:18432
    ds_read_b64_tr_b16 v[50:51], v16 offset:18944
    s_waitcnt lgkmcnt(4)
    v_mfma_f32_32x32x16_bf16 v[136:151], v[40:43], v[36:39], v[136:151]
    ds_read_b128 v[20:23], v14
    ds_read_b64_tr_b16 v[24:25], v16 offset:4096
    s_waitcnt lgkmcnt(4)
    v_mfma_f32_32x32x16_bf16 v[152:167], v[44:47], v[36:39], v[152:167]
    ds_read_b64_tr_b16 v[26:27], v16 offset:4608
    ds_read_b64_tr_b16 v[28:29], v16 offset:12288
    s_waitcnt lgkmcnt(4)
    v_mfma_f32_32x32x16_bf16 v[168:183], v[36:39], v[48:51], v[168:183]
    ds_read_b64_tr_b16 v[30:31], v16 offset:12800
    ds_read_b64_tr_b16 v[32:33], v16 offset:20480
    ds_read_b64_tr_b16 v[34:35], v16 offset:20992
    s_waitcnt lgkmcnt(4)
    v_mfma_f32_32x32x16_bf16 v[136:151], v[24:27], v[20:23], v[136:151]
    ds_read_b128 v[36:39], v15
    ds_read_b64_tr_b16 v[40:41], v16 offset:6144
    s_waitcnt lgkmcnt(4)
    v_mfma_f32_32x32x16_bf16 v[152:167], v[28:31], v[20:23], v[152:167]
    ds_read_b64_tr_b16 v[42:43], v16 offset:6656
    ds_read_b64_tr_b16 v[44:45], v16 offset:14336
    s_waitcnt lgkmcnt(4)
    v_mfma_f32_32x32x16_bf16 v[168:183], v[20:23], v[32:35], v[168:183]
    ds_read_b64_tr_b16 v[46:47], v16 offset:14848
    ds_read_b64_tr_b16 v[48:49], v16 offset:22528
    ds_read_b64_tr_b16 v[50:51], v16 offset:23040
    s_waitcnt lgkmcnt(4)
    v_mfma_f32_32x32x16_bf16 v[136:151], v[40:43], v[36:39], v[136:151]
    s_waitcnt lgkmcnt(2)
    v_mfma_f32_32x32x16_bf16 v[152:167], v[44:47], v[36:39], v[152:167]
    s_waitcnt lgkmcnt(0)
    v_mfma_f32_32x32x16_bf16 v[168:183], v[36:39], v[48:51], v[168:183]
    s_lshl_b32 s61, s47, 2
    s_lshl_b32 s21, s59, 1
    s_add_u32 s61, s61, s21
    s_lshl_b32 s21, s61, 16
    s_lshl_b32 s22, s60, 10
    s_add_u32 s62, s21, s22
    s_nop 7

    v_cvt_pk_bf16_f32 v120, v152, v153
    v_cvt_pk_bf16_f32 v121, v154, v155
    v_cvt_pk_bf16_f32 v122, v156, v157
    v_cvt_pk_bf16_f32 v123, v158, v159
    v_cvt_pk_bf16_f32 v124, v160, v161
    v_cvt_pk_bf16_f32 v125, v162, v163
    v_cvt_pk_bf16_f32 v126, v164, v165
    v_cvt_pk_bf16_f32 v127, v166, v167
    v_cvt_pk_bf16_f32 v128, v168, v169
    v_cvt_pk_bf16_f32 v129, v170, v171
    v_cvt_pk_bf16_f32 v130, v172, v173
    v_cvt_pk_bf16_f32 v131, v174, v175
    v_cvt_pk_bf16_f32 v132, v176, v177
    v_cvt_pk_bf16_f32 v133, v178, v179
    v_cvt_pk_bf16_f32 v134, v180, v181
    v_cvt_pk_bf16_f32 v135, v182, v183
    s_cmp_eq_u32 s58, 1
    s_cbranch_scc0 F_NOHALO
    s_add_u32 s21, s62, 9437184
    buffer_store_dwordx4 v[120:123], v17, s[16:19], s21 offen sc0 sc1
    s_add_u32 s21, s62, 9502720
    buffer_store_dwordx4 v[124:127], v17, s[16:19], s21 offen sc0 sc1
    s_add_u32 s21, s62, 11534336
    buffer_store_dwordx4 v[128:131], v18, s[16:19], s21 offen sc0 sc1
    buffer_store_dwordx4 v[132:135], v18, s[16:19], s21 offen offset:512 sc0 sc1
F_NOHALO:
    v_mul_f32 v136, s27, v136
    v_mul_f32 v137, s27, v137
    v_mul_f32 v138, s27, v138
    v_mul_f32 v139, s27, v139
    v_mul_f32 v140, s27, v140
    v_mul_f32 v141, s27, v141
    v_mul_f32 v142, s27, v142
    v_mul_f32 v143, s27, v143
    v_mul_f32 v144, s27, v144
    v_mul_f32 v145, s27, v145
    v_mul_f32 v146, s27, v146
    v_mul_f32 v147, s27, v147
    v_mul_f32 v148, s27, v148
    v_mul_f32 v149, s27, v149
    v_mul_f32 v150, s27, v150
    v_mul_f32 v151, s27, v151
    v_cvt_pk_bf16_f32 v112, v136, v137
    v_cvt_pk_bf16_f32 v113, v138, v139
    v_cvt_pk_bf16_f32 v114, v140, v141
    v_cvt_pk_bf16_f32 v115, v142, v143
    v_cvt_pk_bf16_f32 v116, v144, v145
    v_cvt_pk_bf16_f32 v117, v146, v147
    v_cvt_pk_bf16_f32 v118, v148, v149
    v_cvt_pk_bf16_f32 v119, v150, v151
    s_lshl_b32 s22, s59, 2
    s_add_u32 s22, s22, s58
    s_lshl_b32 s22, s22, 10
    v_add_u32 v2, s22, v17
    v_add_u32 v3, s22, v19
    v_add_u32 v48, s22, v1
    v_add_u32 v2, 131072, v2
    v_add_u32 v3, 139264, v3
    v_add_u32 v48, 147456, v48

    ds_write_b128 v2, v[120:123] offset:0
    ds_write_b128 v48, v[112:115] offset:0
    ds_write_b128 v2, v[124:127] offset:2048
    ds_write_b128 v48, v[116:119] offset:2048
    ds_write_b128 v3, v[128:131]
    ds_write_b128 v3, v[132:135] offset:512
    s_waitcnt lgkmcnt(0)
    s_branch F_P3PRE
F_LOADER:
    s_sub_u32 s21, s20, 4
    s_or_b32 s22, s2, s21
    s_cmp_eq_u32 s22, 0
    s_cbranch_scc0 F_NONONCE
    s_memrealtime s[22:23]
    s_waitcnt lgkmcnt(0)
    s_or_b32 s22, s22, 1
    v_mov_b32 v2, s22
    v_mov_b32 v3, 0
    s_mov_b64 exec, 1
    buffer_store_dword v2, v3, s[28:31], 0 offen offset:0 sc0 sc1
    s_mov_b64 exec, -1
F_NONONCE:
    v_mov_b32 v3, v240
    v_mov_b32 v9, v241
    v_mov_b32 v10, 0
    s_lshl_b32 s57, s21, 10

    s_add_u32 s22, s49, 0
    s_and_b32 s22, s22, 7
    s_lshl_b32 s23, s22, 7
    s_mul_i32 s24, s22, 196608

    s_add_u32 m0, s57, 65536
    s_add_u32 s25, s23, 0
    buffer_load_dwordx4 v3, s[8:11], s25 offen lds
    s_add_u32 m0, s57, 69632
    s_add_u32 s25, s23, 32768
    buffer_load_dwordx4 v3, s[8:11], s25 offen lds
    s_add_u32 m0, s57, 73728
    s_add_u32 s25, s24, 0
    buffer_load_dwordx4 v9, s[12:15], s25 offen lds
    s_add_u32 m0, s57, 77824
    s_add_u32 s25, s24, 98304
    buffer_load_dwordx4 v9, s[12:15], s25 offen lds
    s_add_u32 m0, s57, 81920
    s_add_u32 s25, s24, 1024
    buffer_load_dwordx4 v9, s[12:15], s25 offen lds
    s_add_u32 m0, s57, 86016
    s_add_u32 s25, s24, 99328
    buffer_load_dwordx4 v9, s[12:15], s25 offen lds
    s_add_u32 m0, s57, 90112
    s_add_u32 s25, s24, 2048
    buffer_load_dwordx4 v9, s[12:15], s25 offen lds
    s_add_u32 m0, s57, 94208
    s_add_u32 s25, s24, 100352
    buffer_load_dwordx4 v9, s[12:15], s25 offen lds
    s_add_u32 s22, s49, 1
    s_and_b32 s22, s22, 7
    s_lshl_b32 s23, s22, 7
    s_mul_i32 s24, s22, 196608

    s_add_u32 m0, s57, 98304
    s_add_u32 s25, s23, 0
    buffer_load_dwordx4 v3, s[8:11], s25 offen lds
    s_add_u32 m0, s57, 102400
    s_add_u32 s25, s23, 32768
    buffer_load_dwordx4 v3, s[8:11], s25 offen lds
    s_add_u32 m0, s57, 106496
    s_add_u32 s25, s24, 0
    buffer_load_dwordx4 v9, s[12:15], s25 offen lds
    s_add_u32 m0, s57, 110592
    s_add_u32 s25, s24, 98304
    buffer_load_dwordx4 v9, s[12:15], s25 offen lds
    s_add_u32 m0, s57, 114688
    s_add_u32 s25, s24, 1024
    buffer_load_dwordx4 v9, s[12:15], s25 offen lds
    s_add_u32 m0, s57, 118784
    s_add_u32 s25, s24, 99328
    buffer_load_dwordx4 v9, s[12:15], s25 offen lds
    s_add_u32 m0, s57, 122880
    s_add_u32 s25, s24, 2048
    buffer_load_dwordx4 v9, s[12:15], s25 offen lds
    s_add_u32 m0, s57, 126976
    s_add_u32 s25, s24, 100352
    buffer_load_dwordx4 v9, s[12:15], s25 offen lds
    v_lshlrev_b32 v12, 2, v0
    s_lshr_b32 s58, s50, 1
    s_lshl_b32 s58, s58, 8
    s_add_u32 s58, s58, 18874368
    s_mov_b32 s59, 0

    s_waitcnt vmcnt(8)
    s_barrier
    s_add_u32 s22, s49, 2
    s_and_b32 s22, s22, 7
    s_lshl_b32 s23, s22, 7
    s_mul_i32 s24, s22, 196608

    s_add_u32 m0, s57, 131072
    s_add_u32 s25, s23, 0
    buffer_load_dwordx4 v3, s[8:11], s25 offen lds
    s_add_u32 m0, s57, 135168
    s_add_u32 s25, s23, 32768
    buffer_load_dwordx4 v3, s[8:11], s25 offen lds
    s_add_u32 m0, s57, 139264
    s_add_u32 s25, s24, 0
    buffer_load_dwordx4 v9, s[12:15], s25 offen lds
    s_add_u32 m0, s57, 143360
    s_add_u32 s25, s24, 98304
    buffer_load_dwordx4 v9, s[12:15], s25 offen lds
    s_add_u32 m0, s57, 147456
    s_add_u32 s25, s24, 1024
    buffer_load_dwordx4 v9, s[12:15], s25 offen lds
    s_add_u32 m0, s57, 151552
    s_add_u32 s25, s24, 99328
    buffer_load_dwordx4 v9, s[12:15], s25 offen lds
    s_add_u32 m0, s57, 155648
    s_add_u32 s25, s24, 2048
    buffer_load_dwordx4 v9, s[12:15], s25 offen lds
    s_add_u32 m0, s57, 159744
    s_add_u32 s25, s24, 100352
    buffer_load_dwordx4 v9, s[12:15], s25 offen lds
    s_waitcnt vmcnt(8)
    s_barrier
    s_add_u32 s22, s49, 3
    s_and_b32 s22, s22, 7
    s_lshl_b32 s23, s22, 7
    s_mul_i32 s24, s22, 196608

    s_add_u32 m0, s57, 65536
    s_add_u32 s25, s23, 0
    buffer_load_dwordx4 v3, s[8:11], s25 offen lds
    s_add_u32 m0, s57, 69632
    s_add_u32 s25, s23, 32768
    buffer_load_dwordx4 v3, s[8:11], s25 offen lds
    s_add_u32 m0, s57, 73728
    s_add_u32 s25, s24, 0
    buffer_load_dwordx4 v9, s[12:15], s25 offen lds
    s_add_u32 m0, s57, 77824
    s_add_u32 s25, s24, 98304
    buffer_load_dwordx4 v9, s[12:15], s25 offen lds
    s_add_u32 m0, s57, 81920
    s_add_u32 s25, s24, 1024
    buffer_load_dwordx4 v9, s[12:15], s25 offen lds
    s_add_u32 m0, s57, 86016
    s_add_u32 s25, s24, 99328
    buffer_load_dwordx4 v9, s[12:15], s25 offen lds
    s_add_u32 m0, s57, 90112
    s_add_u32 s25, s24, 2048
    buffer_load_dwordx4 v9, s[12:15], s25 offen lds
    s_add_u32 m0, s57, 94208
    s_add_u32 s25, s24, 100352
    buffer_load_dwordx4 v9, s[12:15], s25 offen lds
    s_waitcnt vmcnt(8)
    s_barrier
    s_add_u32 s22, s49, 4
    s_and_b32 s22, s22, 7
    s_lshl_b32 s23, s22, 7
    s_mul_i32 s24, s22, 196608

    s_add_u32 m0, s57, 98304
    s_add_u32 s25, s23, 0
    buffer_load_dwordx4 v3, s[8:11], s25 offen lds
    s_add_u32 m0, s57, 102400
    s_add_u32 s25, s23, 32768
    buffer_load_dwordx4 v3, s[8:11], s25 offen lds
    s_add_u32 m0, s57, 106496
    s_add_u32 s25, s24, 0
    buffer_load_dwordx4 v9, s[12:15], s25 offen lds
    s_add_u32 m0, s57, 110592
    s_add_u32 s25, s24, 98304
    buffer_load_dwordx4 v9, s[12:15], s25 offen lds
    s_add_u32 m0, s57, 114688
    s_add_u32 s25, s24, 1024
    buffer_load_dwordx4 v9, s[12:15], s25 offen lds
    s_add_u32 m0, s57, 118784
    s_add_u32 s25, s24, 99328
    buffer_load_dwordx4 v9, s[12:15], s25 offen lds
    s_add_u32 m0, s57, 122880
    s_add_u32 s25, s24, 2048
    buffer_load_dwordx4 v9, s[12:15], s25 offen lds
    s_add_u32 m0, s57, 126976
    s_add_u32 s25, s24, 100352
    buffer_load_dwordx4 v9, s[12:15], s25 offen lds
    s_waitcnt vmcnt(8)
    s_barrier
    s_add_u32 s22, s49, 5
    s_and_b32 s22, s22, 7
    s_lshl_b32 s23, s22, 7
    s_mul_i32 s24, s22, 196608

    s_add_u32 m0, s57, 131072
    s_add_u32 s25, s23, 0
    buffer_load_dwordx4 v3, s[8:11], s25 offen lds
    s_add_u32 m0, s57, 135168
    s_add_u32 s25, s23, 32768
    buffer_load_dwordx4 v3, s[8:11], s25 offen lds
    s_add_u32 m0, s57, 139264
    s_add_u32 s25, s24, 0
    buffer_load_dwordx4 v9, s[12:15], s25 offen lds
    s_add_u32 m0, s57, 143360
    s_add_u32 s25, s24, 98304
    buffer_load_dwordx4 v9, s[12:15], s25 offen lds
    s_add_u32 m0, s57, 147456
    s_add_u32 s25, s24, 1024
    buffer_load_dwordx4 v9, s[12:15], s25 offen lds
    s_add_u32 m0, s57, 151552
    s_add_u32 s25, s24, 99328
    buffer_load_dwordx4 v9, s[12:15], s25 offen lds
    s_add_u32 m0, s57, 155648
    s_add_u32 s25, s24, 2048
    buffer_load_dwordx4 v9, s[12:15], s25 offen lds
    s_add_u32 m0, s57, 159744
    s_add_u32 s25, s24, 100352
    buffer_load_dwordx4 v9, s[12:15], s25 offen lds
    s_waitcnt vmcnt(8)
    s_barrier
    s_add_u32 s22, s49, 6
    s_and_b32 s22, s22, 7
    s_lshl_b32 s23, s22, 7
    s_mul_i32 s24, s22, 196608

    s_add_u32 m0, s57, 65536
    s_add_u32 s25, s23, 0
    buffer_load_dwordx4 v3, s[8:11], s25 offen lds
    s_add_u32 m0, s57, 69632
    s_add_u32 s25, s23, 32768
    buffer_load_dwordx4 v3, s[8:11], s25 offen lds
    s_add_u32 m0, s57, 73728
    s_add_u32 s25, s24, 0
    buffer_load_dwordx4 v9, s[12:15], s25 offen lds
    s_add_u32 m0, s57, 77824
    s_add_u32 s25, s24, 98304
    buffer_load_dwordx4 v9, s[12:15], s25 offen lds
    s_add_u32 m0, s57, 81920
    s_add_u32 s25, s24, 1024
    buffer_load_dwordx4 v9, s[12:15], s25 offen lds
    s_add_u32 m0, s57, 86016
    s_add_u32 s25, s24, 99328
    buffer_load_dwordx4 v9, s[12:15], s25 offen lds
    s_add_u32 m0, s57, 90112
    s_add_u32 s25, s24, 2048
    buffer_load_dwordx4 v9, s[12:15], s25 offen lds
    s_add_u32 m0, s57, 94208
    s_add_u32 s25, s24, 100352
    buffer_load_dwordx4 v9, s[12:15], s25 offen lds
    v_mov_b32 v10, 0
    buffer_load_dword v11, v10, s[28:31], 0 offen offset:0 sc0 sc1
    s_waitcnt vmcnt(8)
    s_barrier
    s_add_u32 s22, s49, 7
    s_and_b32 s22, s22, 7
    s_lshl_b32 s23, s22, 7
    s_mul_i32 s24, s22, 196608

    s_add_u32 m0, s57, 98304
    s_add_u32 s25, s23, 0
    buffer_load_dwordx4 v3, s[8:11], s25 offen lds
    s_add_u32 m0, s57, 102400
    s_add_u32 s25, s23, 32768
    buffer_load_dwordx4 v3, s[8:11], s25 offen lds
    s_add_u32 m0, s57, 106496
    s_add_u32 s25, s24, 0
    buffer_load_dwordx4 v9, s[12:15], s25 offen lds
    s_add_u32 m0, s57, 110592
    s_add_u32 s25, s24, 98304
    buffer_load_dwordx4 v9, s[12:15], s25 offen lds
    s_add_u32 m0, s57, 114688
    s_add_u32 s25, s24, 1024
    buffer_load_dwordx4 v9, s[12:15], s25 offen lds
    s_add_u32 m0, s57, 118784
    s_add_u32 s25, s24, 99328
    buffer_load_dwordx4 v9, s[12:15], s25 offen lds
    s_add_u32 m0, s57, 122880
    s_add_u32 s25, s24, 2048
    buffer_load_dwordx4 v9, s[12:15], s25 offen lds
    s_add_u32 m0, s57, 126976
    s_add_u32 s25, s24, 100352
    buffer_load_dwordx4 v9, s[12:15], s25 offen lds
    s_waitcnt vmcnt(8)
    s_mov_b32 s56, 0
NN_4:
    v_readfirstlane_b32 s46, v11
    s_cmp_lg_u32 s46, 0
    s_cbranch_scc1 NNE_5
    s_add_u32 s56, s56, 1
    s_cmp_gt_u32 s56, 200000
    s_cbranch_scc1 NNE_5
    buffer_load_dword v11, v10, s[28:31], 0 offen offset:0 sc0 sc1
    s_waitcnt vmcnt(0)
    s_branch NN_4
NNE_5:

    s_barrier
    s_mov_b32 s8, s42
    s_and_b32 s9, s43, 0xffff
    s_mov_b32 s10, 0x200000
    s_mov_b32 s11, 0x00020000
    s_mov_b32 s12, s44
    s_and_b32 s13, s45, 0xffff
    s_mov_b32 s14, 0x180000
    s_mov_b32 s15, 0x00020000
    v_mov_b32 v9, v242
    s_add_u32 s22, s49, 0
    s_and_b32 s22, s22, 7
    s_lshl_b32 s23, s22, 7
    s_mul_i32 s24, s22, 196608

    s_add_u32 m0, s57, 131072
    s_add_u32 s25, s23, 0
    buffer_load_dwordx4 v3, s[8:11], s25 offen lds
    s_add_u32 m0, s57, 135168
    s_add_u32 s25, s23, 32768
    buffer_load_dwordx4 v3, s[8:11], s25 offen lds
    s_add_u32 m0, s57, 139264
    s_add_u32 s25, s24, 0
    buffer_load_dwordx4 v9, s[12:15], s25 offen lds
    s_add_u32 m0, s57, 143360
    s_add_u32 s25, s24, 98304
    buffer_load_dwordx4 v9, s[12:15], s25 offen lds
    s_add_u32 m0, s57, 147456
    s_add_u32 s25, s24, 1024
    buffer_load_dwordx4 v9, s[12:15], s25 offen lds
    s_add_u32 m0, s57, 151552
    s_add_u32 s25, s24, 99328
    buffer_load_dwordx4 v9, s[12:15], s25 offen lds
    s_add_u32 m0, s57, 155648
    s_add_u32 s25, s24, 2048
    buffer_load_dwordx4 v9, s[12:15], s25 offen lds
    s_add_u32 m0, s57, 159744
    s_add_u32 s25, s24, 100352
    buffer_load_dwordx4 v9, s[12:15], s25 offen lds
    s_waitcnt vmcnt(8)
    s_barrier
    s_add_u32 s22, s49, 1
    s_and_b32 s22, s22, 7
    s_lshl_b32 s23, s22, 7
    s_mul_i32 s24, s22, 196608

    s_add_u32 m0, s57, 65536
    s_add_u32 s25, s23, 0
    buffer_load_dwordx4 v3, s[8:11], s25 offen lds
    s_add_u32 m0, s57, 69632
    s_add_u32 s25, s23, 32768
    buffer_load_dwordx4 v3, s[8:11], s25 offen lds
    s_add_u32 m0, s57, 73728
    s_add_u32 s25, s24, 0
    buffer_load_dwordx4 v9, s[12:15], s25 offen lds
    s_add_u32 m0, s57, 77824
    s_add_u32 s25, s24, 98304
    buffer_load_dwordx4 v9, s[12:15], s25 offen lds
    s_add_u32 m0, s57, 81920
    s_add_u32 s25, s24, 1024
    buffer_load_dwordx4 v9, s[12:15], s25 offen lds
    s_add_u32 m0, s57, 86016
    s_add_u32 s25, s24, 99328
    buffer_load_dwordx4 v9, s[12:15], s25 offen lds
    s_add_u32 m0, s57, 90112
    s_add_u32 s25, s24, 2048
    buffer_load_dwordx4 v9, s[12:15], s25 offen lds
    s_add_u32 m0, s57, 94208
    s_add_u32 s25, s24, 100352
    buffer_load_dwordx4 v9, s[12:15], s25 offen lds
    s_waitcnt vmcnt(8)
    s_barrier
    s_add_u32 s22, s49, 2
    s_and_b32 s22, s22, 7
    s_lshl_b32 s23, s22, 7
    s_mul_i32 s24, s22, 196608

    s_add_u32 m0, s57, 98304
    s_add_u32 s25, s23, 0
    buffer_load_dwordx4 v3, s[8:11], s25 offen lds
    s_add_u32 m0, s57, 102400
    s_add_u32 s25, s23, 32768
    buffer_load_dwordx4 v3, s[8:11], s25 offen lds
    s_add_u32 m0, s57, 106496
    s_add_u32 s25, s24, 0
    buffer_load_dwordx4 v9, s[12:15], s25 offen lds
    s_add_u32 m0, s57, 110592
    s_add_u32 s25, s24, 98304
    buffer_load_dwordx4 v9, s[12:15], s25 offen lds
    s_add_u32 m0, s57, 114688
    s_add_u32 s25, s24, 1024
    buffer_load_dwordx4 v9, s[12:15], s25 offen lds
    s_add_u32 m0, s57, 118784
    s_add_u32 s25, s24, 99328
    buffer_load_dwordx4 v9, s[12:15], s25 offen lds
    s_add_u32 m0, s57, 122880
    s_add_u32 s25, s24, 2048
    buffer_load_dwordx4 v9, s[12:15], s25 offen lds
    s_add_u32 m0, s57, 126976
    s_add_u32 s25, s24, 100352
    buffer_load_dwordx4 v9, s[12:15], s25 offen lds
    s_waitcnt vmcnt(8)
    s_barrier
    s_add_u32 s22, s49, 3
    s_and_b32 s22, s22, 7
    s_lshl_b32 s23, s22, 7
    s_mul_i32 s24, s22, 196608

    s_add_u32 m0, s57, 131072
    s_add_u32 s25, s23, 0
    buffer_load_dwordx4 v3, s[8:11], s25 offen lds
    s_add_u32 m0, s57, 135168
    s_add_u32 s25, s23, 32768
    buffer_load_dwordx4 v3, s[8:11], s25 offen lds
    s_add_u32 m0, s57, 139264
    s_add_u32 s25, s24, 0
    buffer_load_dwordx4 v9, s[12:15], s25 offen lds
    s_add_u32 m0, s57, 143360
    s_add_u32 s25, s24, 98304
    buffer_load_dwordx4 v9, s[12:15], s25 offen lds
    s_add_u32 m0, s57, 147456
    s_add_u32 s25, s24, 1024
    buffer_load_dwordx4 v9, s[12:15], s25 offen lds
    s_add_u32 m0, s57, 151552
    s_add_u32 s25, s24, 99328
    buffer_load_dwordx4 v9, s[12:15], s25 offen lds
    s_add_u32 m0, s57, 155648
    s_add_u32 s25, s24, 2048
    buffer_load_dwordx4 v9, s[12:15], s25 offen lds
    s_add_u32 m0, s57, 159744
    s_add_u32 s25, s24, 100352
    buffer_load_dwordx4 v9, s[12:15], s25 offen lds
    s_waitcnt vmcnt(8)
    s_barrier
    s_add_u32 s22, s49, 4
    s_and_b32 s22, s22, 7
    s_lshl_b32 s23, s22, 7
    s_mul_i32 s24, s22, 196608

    s_add_u32 m0, s57, 65536
    s_add_u32 s25, s23, 0
    buffer_load_dwordx4 v3, s[8:11], s25 offen lds
    s_add_u32 m0, s57, 69632
    s_add_u32 s25, s23, 32768
    buffer_load_dwordx4 v3, s[8:11], s25 offen lds
    s_add_u32 m0, s57, 73728
    s_add_u32 s25, s24, 0
    buffer_load_dwordx4 v9, s[12:15], s25 offen lds
    s_add_u32 m0, s57, 77824
    s_add_u32 s25, s24, 98304
    buffer_load_dwordx4 v9, s[12:15], s25 offen lds
    s_add_u32 m0, s57, 81920
    s_add_u32 s25, s24, 1024
    buffer_load_dwordx4 v9, s[12:15], s25 offen lds
    s_add_u32 m0, s57, 86016
    s_add_u32 s25, s24, 99328
    buffer_load_dwordx4 v9, s[12:15], s25 offen lds
    s_add_u32 m0, s57, 90112
    s_add_u32 s25, s24, 2048
    buffer_load_dwordx4 v9, s[12:15], s25 offen lds
    s_add_u32 m0, s57, 94208
    s_add_u32 s25, s24, 100352
    buffer_load_dwordx4 v9, s[12:15], s25 offen lds
    s_waitcnt vmcnt(8)
    s_barrier
    s_add_u32 s22, s49, 5
    s_and_b32 s22, s22, 7
    s_lshl_b32 s23, s22, 7
    s_mul_i32 s24, s22, 196608

    s_add_u32 m0, s57, 98304
    s_add_u32 s25, s23, 0
    buffer_load_dwordx4 v3, s[8:11], s25 offen lds
    s_add_u32 m0, s57, 102400
    s_add_u32 s25, s23, 32768
    buffer_load_dwordx4 v3, s[8:11], s25 offen lds
    s_add_u32 m0, s57, 106496
    s_add_u32 s25, s24, 0
    buffer_load_dwordx4 v9, s[12:15], s25 offen lds
    s_add_u32 m0, s57, 110592
    s_add_u32 s25, s24, 98304
    buffer_load_dwordx4 v9, s[12:15], s25 offen lds
    s_add_u32 m0, s57, 114688
    s_add_u32 s25, s24, 1024
    buffer_load_dwordx4 v9, s[12:15], s25 offen lds
    s_add_u32 m0, s57, 118784
    s_add_u32 s25, s24, 99328
    buffer_load_dwordx4 v9, s[12:15], s25 offen lds
    s_add_u32 m0, s57, 122880
    s_add_u32 s25, s24, 2048
    buffer_load_dwordx4 v9, s[12:15], s25 offen lds
    s_add_u32 m0, s57, 126976
    s_add_u32 s25, s24, 100352
    buffer_load_dwordx4 v9, s[12:15], s25 offen lds
    s_waitcnt vmcnt(8)
    s_barrier
    s_add_u32 s22, s49, 6
    s_and_b32 s22, s22, 7
    s_lshl_b32 s23, s22, 7
    s_mul_i32 s24, s22, 196608

    s_add_u32 m0, s57, 131072
    s_add_u32 s25, s23, 0
    buffer_load_dwordx4 v3, s[8:11], s25 offen lds
    s_add_u32 m0, s57, 135168
    s_add_u32 s25, s23, 32768
    buffer_load_dwordx4 v3, s[8:11], s25 offen lds
    s_add_u32 m0, s57, 139264
    s_add_u32 s25, s24, 0
    buffer_load_dwordx4 v9, s[12:15], s25 offen lds
    s_add_u32 m0, s57, 143360
    s_add_u32 s25, s24, 98304
    buffer_load_dwordx4 v9, s[12:15], s25 offen lds
    s_add_u32 m0, s57, 147456
    s_add_u32 s25, s24, 1024
    buffer_load_dwordx4 v9, s[12:15], s25 offen lds
    s_add_u32 m0, s57, 151552
    s_add_u32 s25, s24, 99328
    buffer_load_dwordx4 v9, s[12:15], s25 offen lds
    s_add_u32 m0, s57, 155648
    s_add_u32 s25, s24, 2048
    buffer_load_dwordx4 v9, s[12:15], s25 offen lds
    s_add_u32 m0, s57, 159744
    s_add_u32 s25, s24, 100352
    buffer_load_dwordx4 v9, s[12:15], s25 offen lds
    s_waitcnt vmcnt(8)
    s_barrier
    buffer_load_dword v13, v12, s[16:19], s58 offen sc0 sc1
    s_add_u32 s22, s49, 7
    s_and_b32 s22, s22, 7
    s_lshl_b32 s23, s22, 7
    s_mul_i32 s24, s22, 196608

    s_add_u32 m0, s57, 65536
    s_add_u32 s25, s23, 0
    buffer_load_dwordx4 v3, s[8:11], s25 offen lds
    s_add_u32 m0, s57, 69632
    s_add_u32 s25, s23, 32768
    buffer_load_dwordx4 v3, s[8:11], s25 offen lds
    s_add_u32 m0, s57, 73728
    s_add_u32 s25, s24, 0
    buffer_load_dwordx4 v9, s[12:15], s25 offen lds
    s_add_u32 m0, s57, 77824
    s_add_u32 s25, s24, 98304
    buffer_load_dwordx4 v9, s[12:15], s25 offen lds
    s_add_u32 m0, s57, 81920
    s_add_u32 s25, s24, 1024
    buffer_load_dwordx4 v9, s[12:15], s25 offen lds
    s_add_u32 m0, s57, 86016
    s_add_u32 s25, s24, 99328
    buffer_load_dwordx4 v9, s[12:15], s25 offen lds
    s_add_u32 m0, s57, 90112
    s_add_u32 s25, s24, 2048
    buffer_load_dwordx4 v9, s[12:15], s25 offen lds
    s_add_u32 m0, s57, 94208
    s_add_u32 s25, s24, 100352
    buffer_load_dwordx4 v9, s[12:15], s25 offen lds
    s_waitcnt vmcnt(8)
    v_cmp_ne_u32 vcc, s46, v13
    s_nop 4
    s_cbranch_vccnz F_NRDY
    s_mov_b32 s59, 1
F_NRDY:

    s_barrier
    s_cmp_eq_u32 s59, 1
    s_cbranch_scc0 F_NOEARLY
    s_lshl_b32 s22, s50, 16
    s_add_u32 s22, s22, s57
    s_add_u32 s23, s22, 4194304
    s_lshl_b32 s24, s51, 13
    s_add_u32 s24, s24, s22
    s_add_u32 s24, s24, 0
    s_add_u32 s22, s22, 2097152

    s_add_u32 m0, s57, 98304
    s_add_u32 s25, s24, 0
    buffer_load_dwordx4 v1, s[16:19], s25 offen sc0 sc1 lds
    s_add_u32 m0, s57, 102400
    s_add_u32 s25, s24, 4096
    buffer_load_dwordx4 v1, s[16:19], s25 offen sc0 sc1 lds
    s_add_u32 m0, s57, 0
    s_add_u32 s25, s22, 0
    buffer_load_dwordx4 v1, s[16:19], s25 offen sc0 sc1 lds
    s_add_u32 m0, s57, 32768
    s_add_u32 s25, s23, 0
    buffer_load_dwordx4 v1, s[16:19], s25 offen sc0 sc1 lds
    s_add_u32 m0, s57, 12288
    s_add_u32 s25, s22, 12288
    buffer_load_dwordx4 v1, s[16:19], s25 offen sc0 sc1 lds
    s_add_u32 m0, s57, 45056
    s_add_u32 s25, s23, 12288
    buffer_load_dwordx4 v1, s[16:19], s25 offen sc0 sc1 lds
    s_add_u32 m0, s57, 4096
    s_add_u32 s25, s22, 4096
    buffer_load_dwordx4 v1, s[16:19], s25 offen sc0 sc1 lds
    s_add_u32 m0, s57, 36864
    s_add_u32 s25, s23, 4096
    buffer_load_dwordx4 v1, s[16:19], s25 offen sc0 sc1 lds
    s_add_u32 m0, s57, 16384
    s_add_u32 s25, s22, 16384
    buffer_load_dwordx4 v1, s[16:19], s25 offen sc0 sc1 lds
    s_add_u32 m0, s57, 49152
    s_add_u32 s25, s23, 16384
    buffer_load_dwordx4 v1, s[16:19], s25 offen sc0 sc1 lds
F_NOEARLY:
    s_cmp_eq_u32 s59, 1
    s_cbranch_scc1 F_W15R
    s_waitcnt vmcnt(0)
    s_branch F_W15E
F_W15R:
    s_waitcnt vmcnt(10)
F_W15E:

    s_barrier
    s_cmp_eq_u32 s59, 1
    s_cbranch_scc1 F_KVDONE
    v_lshlrev_b32 v10, 2, v0
    s_mov_b32 s56, 0
POLL_6:
    buffer_load_dword v11, v10, s[16:19], s58 offen sc0 sc1
    s_add_u32 s56, s56, 1
    s_cmp_gt_u32 s56, 200000
    s_cbranch_scc1 POLLE_7
    s_waitcnt vmcnt(0)
    v_cmp_ne_u32 vcc, s46, v11
    s_nop 4
    s_cbranch_vccnz POLL_6
POLLE_7:
    s_waitcnt vmcnt(0)

    s_lshl_b32 s22, s50, 16
    s_add_u32 s22, s22, s57
    s_add_u32 s23, s22, 4194304
    s_lshl_b32 s24, s51, 13
    s_add_u32 s24, s24, s22
    s_add_u32 s24, s24, 0
    s_add_u32 s22, s22, 2097152

    s_add_u32 m0, s57, 98304
    s_add_u32 s25, s24, 0
    buffer_load_dwordx4 v1, s[16:19], s25 offen sc0 sc1 lds
    s_add_u32 m0, s57, 102400
    s_add_u32 s25, s24, 4096
    buffer_load_dwordx4 v1, s[16:19], s25 offen sc0 sc1 lds
    s_add_u32 m0, s57, 0
    s_add_u32 s25, s22, 0
    buffer_load_dwordx4 v1, s[16:19], s25 offen sc0 sc1 lds
    s_add_u32 m0, s57, 32768
    s_add_u32 s25, s23, 0
    buffer_load_dwordx4 v1, s[16:19], s25 offen sc0 sc1 lds
    s_add_u32 m0, s57, 12288
    s_add_u32 s25, s22, 12288
    buffer_load_dwordx4 v1, s[16:19], s25 offen sc0 sc1 lds
    s_add_u32 m0, s57, 45056
    s_add_u32 s25, s23, 12288
    buffer_load_dwordx4 v1, s[16:19], s25 offen sc0 sc1 lds
    s_add_u32 m0, s57, 4096
    s_add_u32 s25, s22, 4096
    buffer_load_dwordx4 v1, s[16:19], s25 offen sc0 sc1 lds
    s_add_u32 m0, s57, 36864
    s_add_u32 s25, s23, 4096
    buffer_load_dwordx4 v1, s[16:19], s25 offen sc0 sc1 lds
    s_add_u32 m0, s57, 16384
    s_add_u32 s25, s22, 16384
    buffer_load_dwordx4 v1, s[16:19], s25 offen sc0 sc1 lds
    s_add_u32 m0, s57, 49152
    s_add_u32 s25, s23, 16384
    buffer_load_dwordx4 v1, s[16:19], s25 offen sc0 sc1 lds
F_KVDONE:
    s_waitcnt vmcnt(0)
F_P3PRE:
    v_mov_b32 v25, v250
    s_and_b32 s58, s20, 3
    s_lshr_b32 s59, s20, 2
    s_lshl_b32 s60, s51, 3
    s_lshl_b32 s21, s58, 1
    s_add_u32 s60, s60, s21
    s_lshl_b32 s57, s58, 10
    s_lshl_b32 s22, s50, 16
    s_add_u32 s22, s22, s57
    s_add_u32 s62, s22, 2129920
    s_add_u32 s63, s22, 4227072
    v_mov_b32 v24, 0xdddd
    v_mov_b32 v29, 0

    s_mov_b32 s8, s40
    s_and_b32 s9, s41, 0xffff
    s_mov_b32 s10, 0x80000
    s_mov_b32 s11, 0x00020000
    s_mov_b32 s12, s38
    s_and_b32 s13, s39, 0xffff
    s_mov_b32 s14, 0x80000
    s_mov_b32 s15, 0x00020000
    v_and_b32 v26, 31, v0
    v_cmp_eq_u32 vcc, 16, v26
    v_mov_b32 v26, 0x3f803f80
    s_nop 0
    v_cndmask_b32 v16, 0, v26, vcc
    v_cndmask_b32 v17, 0, v26, vcc
    v_cndmask_b32 v18, 0, v26, vcc
    v_cndmask_b32 v19, 0, v26, vcc
    v_cndmask_b32 v20, 0, v26, vcc
    v_cndmask_b32 v21, 0, v26, vcc
    v_cndmask_b32 v22, 0, v26, vcc
    v_cndmask_b32 v23, 0, v26, vcc
    v_cndmask_b32 v32, 0, v26, vcc
    v_cndmask_b32 v33, 0, v26, vcc
    v_cndmask_b32 v34, 0, v26, vcc
    v_cndmask_b32 v35, 0, v26, vcc
    v_cndmask_b32 v36, 0, v26, vcc
    v_cndmask_b32 v37, 0, v26, vcc
    v_cndmask_b32 v38, 0, v26, vcc
    v_cndmask_b32 v39, 0, v26, vcc
    v_mov_b32 v80, 0
    v_mov_b32 v81, 0
    v_mov_b32 v82, 0
    v_mov_b32 v83, 0
    v_mov_b32 v84, 0
    v_mov_b32 v85, 0
    v_mov_b32 v86, 0
    v_mov_b32 v87, 0
    v_mov_b32 v88, 0
    v_mov_b32 v112, 0
    v_mov_b32 v113, 0
    v_mov_b32 v114, 0
    v_mov_b32 v115, 0
    v_mov_b32 v116, 0
    v_mov_b32 v117, 0
    v_mov_b32 v118, 0
    v_mov_b32 v119, 0
    v_mov_b32 v120, 0
    s_waitcnt lgkmcnt(0)
    s_barrier
    s_cmp_eq_u32 s59, 0
    s_cbranch_scc1 F_NODEF
    s_lshl_b32 s22, s50, 16
    s_add_u32 s22, s22, s57
    s_add_u32 s23, s22, 4194304
    s_add_u32 s22, s22, 2097152

    s_add_u32 m0, s57, 8192
    s_add_u32 s25, s22, 8192
    buffer_load_dwordx4 v1, s[16:19], s25 offen sc0 sc1 lds
    s_add_u32 m0, s57, 40960
    s_add_u32 s25, s23, 8192
    buffer_load_dwordx4 v1, s[16:19], s25 offen sc0 sc1 lds
    s_add_u32 m0, s57, 20480
    s_add_u32 s25, s22, 20480
    buffer_load_dwordx4 v1, s[16:19], s25 offen sc0 sc1 lds
    s_add_u32 m0, s57, 53248
    s_add_u32 s25, s23, 20480
    buffer_load_dwordx4 v1, s[16:19], s25 offen sc0 sc1 lds
    s_add_u32 m0, s57, 24576
    s_add_u32 s25, s22, 24576
    buffer_load_dwordx4 v1, s[16:19], s25 offen sc0 sc1 lds
    s_add_u32 m0, s57, 57344
    s_add_u32 s25, s23, 24576
    buffer_load_dwordx4 v1, s[16:19], s25 offen sc0 sc1 lds
    s_add_u32 m0, s57, 28672
    s_add_u32 s25, s22, 28672
    buffer_load_dwordx4 v1, s[16:19], s25 offen sc0 sc1 lds
    s_add_u32 m0, s57, 61440
    s_add_u32 s25, s23, 28672
    buffer_load_dwordx4 v1, s[16:19], s25 offen sc0 sc1 lds
F_NODEF:
    s_add_u32 s3, s60, s59
    s_lshl_b32 s3, s3, 5
    s_add_u32 s3, s3, s50
    v_mov_b32 v48, -1
    v_mov_b32 v49, -1
    v_mov_b32 v50, -1
    v_mov_b32 v51, -1
    s_lshl_b32 s21, s3, 10
    s_add_u32 s21, s21, 14680064
    buffer_store_dwordx4 v[48:51], v1, s[16:19], s21 offen sc0 sc1

    s_lshl_b32 s21, s58, 11
    s_add_u32 s21, s21, 98304
    v_add_u32 v26, s21, v1
    ds_read_b128 v[4:7], v26
    ds_read_b128 v[8:11], v26 offset:1024
    ds_read_b128 v[12:15], v1 offset:0
    s_mov_b32 s7, 0
    s_cmp_eq_u32 s59, 0
    s_cselect_b32 s7, 127, 1
    s_cselect_b32 s5, 3, 5
    s_mov_b32 s4, 0
    s_waitcnt lgkmcnt(0)

    s_mov_b32 s61, 0
F_HALF:
    s_lshl_b32 s21, s61, 16
    s_cmp_eq_u32 s61, 0
    s_cselect_b32 s22, 6, 8
    s_lshl_b32 s22, s22, 11
    s_mul_i32 s22, s22, s59
    s_add_u32 s21, s21, s22
    v_add_u32 v2, s21, v1
    s_add_u32 s21, s21, 32768
    v_add_u32 v3, s21, v25

    v_mov_b32 v72, 0
    v_mov_b32 v73, 0
    v_mov_b32 v74, 0
    v_mov_b32 v75, 0
    v_mov_b32 v76, 0
    v_mov_b32 v77, 0
    v_mov_b32 v78, 0
    v_mov_b32 v79, 0
    ds_read_b128 v[12:15], v2
    s_mov_b64 exec, s[54:55]
    ds_read_b128 v[16:19], v3
    ds_read_b128 v[20:23], v3 offset:512
    s_mov_b64 exec, -1
    s_waitcnt lgkmcnt(2)
    v_mfma_f32_32x32x16_bf16 v[48:63], v[12:15], v[4:7], 0
    s_mov_b32 s58, 0
    s_waitcnt lgkmcnt(0)
    s_nop 13

F_LOOP:
    v_exp_f32 v48, v48
    v_exp_f32 v49, v49
    v_smfmac_f32_32x32x32_bf16 v[112:127], v[36:39], v[72:79], v24
    v_exp_f32 v50, v50
    v_exp_f32 v51, v51
    v_exp_f32 v52, v52
    v_exp_f32 v53, v53
    v_exp_f32 v54, v54
    v_mfma_f32_32x32x16_bf16 v[64:79], v[12:15], v[8:11], 0
    ds_read_b128 v[12:15], v2 offset:1024
    s_mov_b64 exec, s[54:55]
    ds_read_b128 v[32:35], v3 offset:1024
    ds_read_b128 v[36:39], v3 offset:1536
    s_mov_b64 exec, -1
    v_exp_f32 v55, v55
    v_exp_f32 v56, v56
    v_exp_f32 v57, v57
    v_exp_f32 v58, v58
    v_exp_f32 v59, v59
    v_smfmac_f32_32x32x32_bf16 v[80:95], v[16:19], v[48:55], v24
    v_exp_f32 v60, v60
    v_exp_f32 v61, v61
    v_exp_f32 v62, v62
    v_exp_f32 v63, v63
    v_exp_f32 v64, v64
    v_exp_f32 v65, v65
    v_smfmac_f32_32x32x32_bf16 v[80:95], v[20:23], v[56:63], v24
    v_exp_f32 v66, v66
    v_exp_f32 v67, v67
    v_exp_f32 v68, v68
    v_exp_f32 v69, v69
    s_waitcnt lgkmcnt(2)
    v_mfma_f32_32x32x16_bf16 v[48:63], v[12:15], v[4:7], 0
    v_exp_f32 v70, v70
    v_exp_f32 v71, v71
    v_exp_f32 v72, v72
    v_exp_f32 v73, v73
    v_exp_f32 v74, v74
    v_exp_f32 v75, v75
    v_smfmac_f32_32x32x32_bf16 v[112:127], v[16:19], v[64:71], v24
    v_exp_f32 v76, v76
    v_exp_f32 v77, v77
    v_exp_f32 v78, v78
    s_waitcnt lgkmcnt(0)
    v_exp_f32 v79, v79
    v_exp_f32 v48, v48
    v_exp_f32 v49, v49
    v_smfmac_f32_32x32x32_bf16 v[112:127], v[20:23], v[72:79], v24
    v_exp_f32 v50, v50
    v_exp_f32 v51, v51
    v_exp_f32 v52, v52
    v_exp_f32 v53, v53
    v_exp_f32 v54, v54
    v_mfma_f32_32x32x16_bf16 v[64:79], v[12:15], v[8:11], 0
    ds_read_b128 v[12:15], v2 offset:2048
    s_mov_b64 exec, s[54:55]
    ds_read_b128 v[16:19], v3 offset:2048
    ds_read_b128 v[20:23], v3 offset:2560
    s_mov_b64 exec, -1
    v_exp_f32 v55, v55
    v_exp_f32 v56, v56
    v_exp_f32 v57, v57
    v_exp_f32 v58, v58
    v_exp_f32 v59, v59
    v_smfmac_f32_32x32x32_bf16 v[80:95], v[32:35], v[48:55], v24
    v_exp_f32 v60, v60
    v_exp_f32 v61, v61
    v_exp_f32 v62, v62
    v_exp_f32 v63, v63
    v_exp_f32 v64, v64
    v_exp_f32 v65, v65
    v_smfmac_f32_32x32x32_bf16 v[80:95], v[36:39], v[56:63], v24
    v_exp_f32 v66, v66
    v_exp_f32 v67, v67
    v_exp_f32 v68, v68
    v_exp_f32 v69, v69
    s_waitcnt lgkmcnt(2)
    v_mfma_f32_32x32x16_bf16 v[48:63], v[12:15], v[4:7], 0
    v_exp_f32 v70, v70
    v_exp_f32 v71, v71
    v_exp_f32 v72, v72
    v_exp_f32 v73, v73
    v_exp_f32 v74, v74
    v_exp_f32 v75, v75
    v_smfmac_f32_32x32x32_bf16 v[112:127], v[32:35], v[64:71], v24
    v_exp_f32 v76, v76
    v_exp_f32 v77, v77
    v_exp_f32 v78, v78
    s_waitcnt lgkmcnt(0)
    v_exp_f32 v79, v79
    v_exp_f32 v48, v48
    v_exp_f32 v49, v49
    v_smfmac_f32_32x32x32_bf16 v[112:127], v[36:39], v[72:79], v24
    v_exp_f32 v50, v50
    v_exp_f32 v51, v51
    v_exp_f32 v52, v52
    v_exp_f32 v53, v53
    v_exp_f32 v54, v54
    v_mfma_f32_32x32x16_bf16 v[64:79], v[12:15], v[8:11], 0
    ds_read_b128 v[12:15], v2 offset:3072
    s_mov_b64 exec, s[54:55]
    ds_read_b128 v[32:35], v3 offset:3072
    ds_read_b128 v[36:39], v3 offset:3584
    s_mov_b64 exec, -1
    v_exp_f32 v55, v55
    v_exp_f32 v56, v56
    v_exp_f32 v57, v57
    v_exp_f32 v58, v58
    v_exp_f32 v59, v59
    v_smfmac_f32_32x32x32_bf16 v[80:95], v[16:19], v[48:55], v24
    v_exp_f32 v60, v60
    v_exp_f32 v61, v61
    v_exp_f32 v62, v62
    v_exp_f32 v63, v63
    v_exp_f32 v64, v64
    v_exp_f32 v65, v65
    v_smfmac_f32_32x32x32_bf16 v[80:95], v[20:23], v[56:63], v24
    v_exp_f32 v66, v66
    v_exp_f32 v67, v67
    v_exp_f32 v68, v68
    v_exp_f32 v69, v69
    s_waitcnt lgkmcnt(2)
    v_mfma_f32_32x32x16_bf16 v[48:63], v[12:15], v[4:7], 0
    v_exp_f32 v70, v70
    v_exp_f32 v71, v71
    v_exp_f32 v72, v72
    v_exp_f32 v73, v73
    v_exp_f32 v74, v74
    v_exp_f32 v75, v75
    v_smfmac_f32_32x32x32_bf16 v[112:127], v[16:19], v[64:71], v24
    v_exp_f32 v76, v76
    v_exp_f32 v77, v77
    v_exp_f32 v78, v78
    s_waitcnt lgkmcnt(0)
    v_exp_f32 v79, v79
    v_exp_f32 v48, v48
    v_exp_f32 v49, v49
    v_smfmac_f32_32x32x32_bf16 v[112:127], v[20:23], v[72:79], v24
    v_exp_f32 v50, v50
    v_exp_f32 v51, v51
    v_exp_f32 v52, v52
    v_exp_f32 v53, v53
    v_exp_f32 v54, v54
    v_mfma_f32_32x32x16_bf16 v[64:79], v[12:15], v[8:11], 0
    ds_read_b128 v[12:15], v2 offset:4096
    s_mov_b64 exec, s[54:55]
    ds_read_b128 v[16:19], v3 offset:4096
    ds_read_b128 v[20:23], v3 offset:4608
    s_mov_b64 exec, -1
    v_exp_f32 v55, v55
    v_exp_f32 v56, v56
    v_exp_f32 v57, v57
    v_exp_f32 v58, v58
    v_exp_f32 v59, v59
    v_smfmac_f32_32x32x32_bf16 v[80:95], v[32:35], v[48:55], v24
    v_exp_f32 v60, v60
    v_exp_f32 v61, v61
    v_exp_f32 v62, v62
    v_exp_f32 v63, v63
    v_exp_f32 v64, v64
    v_exp_f32 v65, v65
    v_smfmac_f32_32x32x32_bf16 v[80:95], v[36:39], v[56:63], v24
    v_exp_f32 v66, v66
    v_exp_f32 v67, v67
    v_exp_f32 v68, v68
    v_exp_f32 v69, v69
    s_waitcnt lgkmcnt(2)
    v_mfma_f32_32x32x16_bf16 v[48:63], v[12:15], v[4:7], 0
    v_exp_f32 v70, v70
    v_exp_f32 v71, v71
    v_exp_f32 v72, v72
    v_exp_f32 v73, v73
    v_exp_f32 v74, v74
    v_exp_f32 v75, v75
    v_smfmac_f32_32x32x32_bf16 v[112:127], v[32:35], v[64:71], v24
    v_exp_f32 v76, v76
    v_exp_f32 v77, v77
    v_exp_f32 v78, v78
    s_waitcnt lgkmcnt(0)
    v_exp_f32 v79, v79
    v_add_u32 v2, 4096, v2
    v_add_u32 v3, 4096, v3
    s_add_u32 s58, s58, 1
    s_bitcmp1_b32 s7, 0
    s_cbranch_scc1 F_JOBS
F_JEND:
    s_lshr_b32 s7, s7, 1
    s_cmp_lt_u32 s58, s5
    s_cbranch_scc1 F_LOOP

    s_waitcnt lgkmcnt(0)
    v_smfmac_f32_32x32x32_bf16 v[112:127], v[36:39], v[72:79], v24
    s_cmp_eq_u32 s61, 1
    s_cbranch_scc1 F_ATT_END

    s_cmp_eq_u32 s59, 0
    s_cbranch_scc0 F_PREX1
    s_lshl_b32 s23, s20, 1
    s_add_u32 s23, s23, 1
    s_lshl_b32 s23, s23, 10
    v_add_u32 v26, s23, v1
    v_add_u32 v27, s23, v25
    v_add_u32 v26, 131072, v26
    v_add_u32 v27, 131072, v27
    ds_read_b128 v[204:207], v26 offset:16384
    ds_read_b128 v[188:191], v26 offset:0

    v_and_b32 v28, 31, v0
    v_cmp_eq_u32 vcc, 16, v28
    v_mov_b32 v28, 0x3f803f80
    s_nop 0
    v_cndmask_b32 v192, 0, v28, vcc
    v_cndmask_b32 v193, 0, v28, vcc
    v_cndmask_b32 v194, 0, v28, vcc
    v_cndmask_b32 v195, 0, v28, vcc
    v_cndmask_b32 v196, 0, v28, vcc
    v_cndmask_b32 v197, 0, v28, vcc
    v_cndmask_b32 v198, 0, v28, vcc
    v_cndmask_b32 v199, 0, v28, vcc
    v_cndmask_b32 v200, 0, v28, vcc
    v_cndmask_b32 v201, 0, v28, vcc
    v_cndmask_b32 v202, 0, v28, vcc
    v_cndmask_b32 v203, 0, v28, vcc
    s_mov_b64 exec, s[54:55]
    ds_read_b128 v[196:199], v27 offset:8192
    ds_read_b128 v[200:203], v27 offset:8704
    s_mov_b64 exec, -1

    v_subrev_u32 v26, 1024, v26
    v_subrev_u32 v27, 1024, v27
    ds_read_b128 v[184:187], v26 offset:0
    s_mov_b64 exec, s[54:55]
    ds_read_b128 v[192:195], v27 offset:8704
    s_mov_b64 exec, -1
    v_mov_b32 v31, 0xff800000

    s_mov_b32 s26, 0x0
    s_mov_b32 s27, 0x55
    v_cndmask_b32 v160, v31, 0, s[26:27]
    s_mov_b32 s26, 0x0
    s_mov_b32 s27, 0xaa
    v_cndmask_b32 v161, v31, 0, s[26:27]
    s_mov_b32 s26, 0x1
    s_mov_b32 s27, 0x155
    v_cndmask_b32 v162, v31, 0, s[26:27]
    s_mov_b32 s26, 0x2
    s_mov_b32 s27, 0x2aa
    v_cndmask_b32 v163, v31, 0, s[26:27]
    s_mov_b32 s26, 0x5
    s_mov_b32 s27, 0x555
    v_cndmask_b32 v164, v31, 0, s[26:27]
    s_mov_b32 s26, 0xa
    s_mov_b32 s27, 0xaaa
    v_cndmask_b32 v165, v31, 0, s[26:27]
    s_mov_b32 s26, 0x15
    s_mov_b32 s27, 0x1555
    v_cndmask_b32 v166, v31, 0, s[26:27]
    s_mov_b32 s26, 0x2a
    s_mov_b32 s27, 0x2aaa
    v_cndmask_b32 v167, v31, 0, s[26:27]
    s_mov_b32 s26, 0x5555
    s_mov_b32 s27, 0x555500
    v_cndmask_b32 v168, v31, 0, s[26:27]
    s_mov_b32 s26, 0xaaaa
    s_mov_b32 s27, 0xaaaa00
    v_cndmask_b32 v169, v31, 0, s[26:27]
    s_mov_b32 s26, 0x15554
    s_mov_b32 s27, 0x1555400
    v_cndmask_b32 v170, v31, 0, s[26:27]
    s_mov_b32 s26, 0x2aaa8
    s_mov_b32 s27, 0x2aaa800
    v_cndmask_b32 v171, v31, 0, s[26:27]
    s_mov_b32 s26, 0x55550
    s_mov_b32 s27, 0x5555000
    v_cndmask_b32 v172, v31, 0, s[26:27]
    s_mov_b32 s26, 0xaaaa0
    s_mov_b32 s27, 0xaaaa000
    v_cndmask_b32 v173, v31, 0, s[26:27]
    s_mov_b32 s26, 0x155540
    s_mov_b32 s27, 0x15554000
    v_cndmask_b32 v174, v31, 0, s[26:27]
    s_mov_b32 s26, 0x2aaa80
    s_mov_b32 s27, 0x2aaa8000
    v_cndmask_b32 v175, v31, 0, s[26:27]
    s_mov_b32 s26, 0x55550000
    s_mov_b32 s27, 0x55000000
    v_cndmask_b32 v176, v31, 0, s[26:27]
    s_mov_b32 s26, 0xaaaa0000
    s_mov_b32 s27, 0xaa000000
    v_cndmask_b32 v177, v31, 0, s[26:27]
    s_mov_b32 s26, 0x55540000
    s_mov_b32 s27, 0x54000000
    v_cndmask_b32 v178, v31, 0, s[26:27]
    s_mov_b32 s26, 0xaaa80000
    s_mov_b32 s27, 0xa8000000
    v_cndmask_b32 v179, v31, 0, s[26:27]
    s_mov_b32 s26, 0x55500000
    s_mov_b32 s27, 0x50000000
    v_cndmask_b32 v180, v31, 0, s[26:27]
    s_mov_b32 s26, 0xaaa00000
    s_mov_b32 s27, 0xa0000000
    v_cndmask_b32 v181, v31, 0, s[26:27]
    s_mov_b32 s26, 0x55400000
    s_mov_b32 s27, 0x40000000
    v_cndmask_b32 v182, v31, 0, s[26:27]
    s_mov_b32 s26, 0xaa800000
    s_mov_b32 s27, 0x80000000
    v_cndmask_b32 v183, v31, 0, s[26:27]
    s_waitcnt lgkmcnt(0)
    v_mfma_f32_32x32x16_bf16 v[48:63], v[184:187], v[204:207], v[152:167]
    v_mfma_f32_32x32x16_bf16 v[64:79], v[188:191], v[204:207], v[168:183]

    v_mov_b32 v136, 0
    v_mov_b32 v137, 0
    v_mov_b32 v138, 0
    v_mov_b32 v139, 0
    v_mov_b32 v140, 0
    v_mov_b32 v141, 0
    v_mov_b32 v142, 0
    v_mov_b32 v143, 0
    v_mov_b32 v144, 0
    s_nop 7
    v_max3_f32 v26, v56, v57, v58
    v_max3_f32 v27, v68, v69, v70
    v_max3_f32 v26, v26, v59, v60
    v_max3_f32 v27, v27, v71, v72
    v_max3_f32 v26, v26, v61, v62
    v_max3_f32 v27, v27, v73, v74
    v_max3_f32 v26, v26, v63, v64
    v_max3_f32 v27, v27, v75, v76
    v_max3_f32 v26, v26, v65, v66
    v_max3_f32 v27, v27, v77, v78
    v_max_f32 v26, v26, v67
    v_max_f32 v27, v27, v79
    v_max_f32 v26, v26, v27
    v_mov_b32 v27, v26
    s_nop 1
    v_permlane32_swap_b32 v26, v27
    s_nop 1
    v_max_f32 v26, v26, v27

    v_mov_b32 v27, v26
    v_pk_add_f32 v[56:57], v[56:57], v[26:27] neg_lo:[0,1] neg_hi:[0,1]
    v_pk_add_f32 v[58:59], v[58:59], v[26:27] neg_lo:[0,1] neg_hi:[0,1]
    v_pk_add_f32 v[60:61], v[60:61], v[26:27] neg_lo:[0,1] neg_hi:[0,1]
    v_pk_add_f32 v[62:63], v[62:63], v[26:27] neg_lo:[0,1] neg_hi:[0,1]
    v_pk_add_f32 v[64:65], v[64:65], v[26:27] neg_lo:[0,1] neg_hi:[0,1]
    v_pk_add_f32 v[66:67], v[66:67], v[26:27] neg_lo:[0,1] neg_hi:[0,1]
    v_pk_add_f32 v[68:69], v[68:69], v[26:27] neg_lo:[0,1] neg_hi:[0,1]
    v_pk_add_f32 v[70:71], v[70:71], v[26:27] neg_lo:[0,1] neg_hi:[0,1]
    v_pk_add_f32 v[72:73], v[72:73], v[26:27] neg_lo:[0,1] neg_hi:[0,1]
    v_pk_add_f32 v[74:75], v[74:75], v[26:27] neg_lo:[0,1] neg_hi:[0,1]
    v_pk_add_f32 v[76:77], v[76:77], v[26:27] neg_lo:[0,1] neg_hi:[0,1]
    v_pk_add_f32 v[78:79], v[78:79], v[26:27] neg_lo:[0,1] neg_hi:[0,1]
    v_exp_f32 v56, v56
    v_exp_f32 v57, v57
    v_exp_f32 v58, v58
    v_exp_f32 v59, v59
    v_exp_f32 v60, v60
    v_exp_f32 v61, v61
    v_exp_f32 v62, v62
    v_exp_f32 v63, v63
    v_exp_f32 v64, v64
    v_exp_f32 v65, v65
    v_exp_f32 v66, v66
    v_exp_f32 v67, v67
    v_exp_f32 v68, v68
    v_exp_f32 v69, v69
    v_exp_f32 v70, v70
    v_exp_f32 v71, v71
    v_exp_f32 v72, v72
    v_exp_f32 v73, v73
    v_exp_f32 v74, v74
    v_exp_f32 v75, v75
    v_exp_f32 v76, v76
    v_exp_f32 v77, v77
    v_exp_f32 v78, v78
    v_exp_f32 v79, v79
    s_nop 1
    v_smfmac_f32_32x32x32_bf16 v[136:151], v[192:195], v[56:63], v24
    v_smfmac_f32_32x32x32_bf16 v[136:151], v[196:199], v[64:71], v24
    v_smfmac_f32_32x32x32_bf16 v[136:151], v[200:203], v[72:79], v24
    s_lshl_b32 s23, s48, 1
    s_add_u32 s23, s23, 1
    s_lshl_b32 s23, s23, 5
    s_lshl_b32 s24, s47, 2
    s_add_u32 s24, s24, s20
    s_add_u32 s6, s23, s24
    s_lshl_b32 s23, s6, 10
    s_add_u32 s23, s23, 16777216
    s_nop 10

    v_mov_b32 v26, v144
    v_mov_b32 v27, v144
    s_nop 1
    v_permlane32_swap_b32 v26, v27
    s_nop 1
    v_rcp_f32 v26, v26
    s_nop 0

    v_mul_f32 v136, v136, v26
    v_mul_f32 v137, v137, v26
    v_mul_f32 v138, v138, v26
    v_mul_f32 v139, v139, v26
    v_mul_f32 v140, v140, v26
    v_mul_f32 v141, v141, v26
    v_mul_f32 v142, v142, v26
    v_mul_f32 v143, v143, v26
    v_cvt_pk_bf16_f32 v144, v136, v137
    v_cvt_pk_bf16_f32 v145, v138, v139
    v_cvt_pk_bf16_f32 v146, v140, v141
    v_cvt_pk_bf16_f32 v147, v142, v143
    buffer_store_dwordx4 v[144:147], v1, s[16:19], s23 offen sc0 sc1
    s_waitcnt vmcnt(1)
    v_mov_b32 v184, v208
    v_mov_b32 v192, v212
    v_mov_b32 v185, v209
    v_mov_b32 v193, v213
    v_mov_b32 v186, v210
    v_mov_b32 v194, v214
    v_mov_b32 v187, v211
    v_mov_b32 v195, v215
    s_cmp_eq_u32 s48, 0
    s_cbranch_scc0 HF_8
    v_mov_b32 v160, 0xff800000
    v_mov_b32 v161, 0xff800000
    v_mov_b32 v162, 0xff800000
    v_mov_b32 v163, 0xff800000
    v_mov_b32 v164, 0xff800000
    v_mov_b32 v165, 0xff800000
    v_mov_b32 v166, 0xff800000
    v_mov_b32 v167, 0xff800000
HF_8:
    s_lshl_b32 s23, s20, 1
    s_add_u32 s23, s23, 0
    s_lshl_b32 s23, s23, 10
    v_add_u32 v26, s23, v1
    v_add_u32 v27, s23, v25
    v_add_u32 v26, 131072, v26
    v_add_u32 v27, 131072, v27
    ds_read_b128 v[204:207], v26 offset:16384
    ds_read_b128 v[188:191], v26 offset:0

    s_mov_b64 exec, s[54:55]
    ds_read_b128 v[196:199], v27 offset:8192
    ds_read_b128 v[200:203], v27 offset:8704
    s_mov_b64 exec, -1

    s_waitcnt lgkmcnt(0)
    v_mfma_f32_32x32x16_bf16 v[48:63], v[184:187], v[204:207], v[152:167]
    v_mfma_f32_32x32x16_bf16 v[64:79], v[188:191], v[204:207], v[168:183]

    v_mov_b32 v136, 0
    v_mov_b32 v137, 0
    v_mov_b32 v138, 0
    v_mov_b32 v139, 0
    v_mov_b32 v140, 0
    v_mov_b32 v141, 0
    v_mov_b32 v142, 0
    v_mov_b32 v143, 0
    v_mov_b32 v144, 0
    s_nop 7
    v_max3_f32 v26, v56, v57, v58
    v_max3_f32 v27, v68, v69, v70
    v_max3_f32 v26, v26, v59, v60
    v_max3_f32 v27, v27, v71, v72
    v_max3_f32 v26, v26, v61, v62
    v_max3_f32 v27, v27, v73, v74
    v_max3_f32 v26, v26, v63, v64
    v_max3_f32 v27, v27, v75, v76
    v_max3_f32 v26, v26, v65, v66
    v_max3_f32 v27, v27, v77, v78
    v_max_f32 v26, v26, v67
    v_max_f32 v27, v27, v79
    v_max_f32 v26, v26, v27
    v_mov_b32 v27, v26
    s_nop 1
    v_permlane32_swap_b32 v26, v27
    s_nop 1
    v_max_f32 v26, v26, v27

    v_mov_b32 v27, v26
    v_pk_add_f32 v[56:57], v[56:57], v[26:27] neg_lo:[0,1] neg_hi:[0,1]
    v_pk_add_f32 v[58:59], v[58:59], v[26:27] neg_lo:[0,1] neg_hi:[0,1]
    v_pk_add_f32 v[60:61], v[60:61], v[26:27] neg_lo:[0,1] neg_hi:[0,1]
    v_pk_add_f32 v[62:63], v[62:63], v[26:27] neg_lo:[0,1] neg_hi:[0,1]
    v_pk_add_f32 v[64:65], v[64:65], v[26:27] neg_lo:[0,1] neg_hi:[0,1]
    v_pk_add_f32 v[66:67], v[66:67], v[26:27] neg_lo:[0,1] neg_hi:[0,1]
    v_pk_add_f32 v[68:69], v[68:69], v[26:27] neg_lo:[0,1] neg_hi:[0,1]
    v_pk_add_f32 v[70:71], v[70:71], v[26:27] neg_lo:[0,1] neg_hi:[0,1]
    v_pk_add_f32 v[72:73], v[72:73], v[26:27] neg_lo:[0,1] neg_hi:[0,1]
    v_pk_add_f32 v[74:75], v[74:75], v[26:27] neg_lo:[0,1] neg_hi:[0,1]
    v_pk_add_f32 v[76:77], v[76:77], v[26:27] neg_lo:[0,1] neg_hi:[0,1]
    v_pk_add_f32 v[78:79], v[78:79], v[26:27] neg_lo:[0,1] neg_hi:[0,1]
    v_exp_f32 v56, v56
    v_exp_f32 v57, v57
    v_exp_f32 v58, v58
    v_exp_f32 v59, v59
    v_exp_f32 v60, v60
    v_exp_f32 v61, v61
    v_exp_f32 v62, v62
    v_exp_f32 v63, v63
    v_exp_f32 v64, v64
    v_exp_f32 v65, v65
    v_exp_f32 v66, v66
    v_exp_f32 v67, v67
    v_exp_f32 v68, v68
    v_exp_f32 v69, v69
    v_exp_f32 v70, v70
    v_exp_f32 v71, v71
    v_exp_f32 v72, v72
    v_exp_f32 v73, v73
    v_exp_f32 v74, v74
    v_exp_f32 v75, v75
    v_exp_f32 v76, v76
    v_exp_f32 v77, v77
    v_exp_f32 v78, v78
    v_exp_f32 v79, v79
    s_nop 1
    v_smfmac_f32_32x32x32_bf16 v[136:151], v[192:195], v[56:63], v24
    v_smfmac_f32_32x32x32_bf16 v[136:151], v[196:199], v[64:71], v24
    v_smfmac_f32_32x32x32_bf16 v[136:151], v[200:203], v[72:79], v24
    s_lshl_b32 s23, s48, 1
    s_add_u32 s23, s23, 0
    s_lshl_b32 s23, s23, 5
    s_lshl_b32 s24, s47, 2
    s_add_u32 s24, s24, s20
    s_add_u32 s6, s23, s24
    s_lshl_b32 s23, s6, 10
    s_add_u32 s23, s23, 16777216
    s_nop 10

    v_mov_b32 v26, v144
    v_mov_b32 v27, v144
    s_nop 1
    v_permlane32_swap_b32 v26, v27
    s_nop 1
    v_rcp_f32 v26, v26
    s_nop 0

    v_mul_f32 v136, v136, v26
    v_mul_f32 v137, v137, v26
    v_mul_f32 v138, v138, v26
    v_mul_f32 v139, v139, v26
    v_mul_f32 v140, v140, v26
    v_mul_f32 v141, v141, v26
    v_mul_f32 v142, v142, v26
    v_mul_f32 v143, v143, v26
    v_cvt_pk_bf16_f32 v144, v136, v137
    v_cvt_pk_bf16_f32 v145, v138, v139
    v_cvt_pk_bf16_f32 v146, v140, v141
    v_cvt_pk_bf16_f32 v147, v142, v143
    buffer_store_dwordx4 v[144:147], v1, s[16:19], s23 offen sc0 sc1
    v_lshlrev_b32 v26, 7, v0
    v_mov_b32 v27, s46
    s_lshl_b32 s21, s6, 2
    s_add_u32 s21, s21, 18890752
    s_waitcnt vmcnt(0)
    s_mov_b64 exec, 3
    buffer_store_dword v27, v26, s[16:19], s21 offen sc0 sc1
    s_mov_b64 exec, -1
F_PREX1:
    s_waitcnt vmcnt(0)

    s_lshl_b32 s21, s3, 2
    s_add_u32 s21, s21, 18898944
    v_mov_b32 v30, s46
    v_mov_b32 v31, 0
    s_mov_b64 exec, 1
    buffer_store_dword v30, v31, s[16:19], s21 offen sc0 sc1
    s_mov_b64 exec, -1

    s_barrier
    s_cmp_eq_u32 s59, 0
    s_cselect_b32 s5, 4, 4
    s_mov_b32 s61, 1
    s_branch F_HALF
F_JOBS:
    s_add_u32 s4, s4, 1
    s_cmp_eq_u32 s4, 1
    s_cbranch_scc1 F_J1
    s_cmp_eq_u32 s4, 2
    s_cbranch_scc1 F_J2
    s_cmp_eq_u32 s4, 3
    s_cbranch_scc1 F_J3
    s_cmp_eq_u32 s4, 4
    s_cbranch_scc1 F_J5
    s_cmp_eq_u32 s4, 5
    s_cbranch_scc1 F_J6
    s_cmp_eq_u32 s4, 6
    s_cbranch_scc1 F_J7
    s_branch F_J8

F_J1:
    s_cmp_eq_u32 s59, 0
    s_cbranch_scc1 F_J1A
    s_waitcnt vmcnt(0)
    s_barrier
    s_branch F_JEND
F_J1A:
    s_barrier

    s_and_b32 s21, s20, 1
    s_cmp_eq_u32 s21, 1
    s_cbranch_scc0 F_J1B
    s_lshl_b32 s21, s47, 5
    s_add_u32 s21, s21, s48
    s_lshl_b32 s21, s21, 1
    s_lshr_b32 s22, s20, 1
    s_add_u32 s21, s21, s22
    s_lshl_b32 s21, s21, 2
    s_add_u32 s21, s21, 18878464
    s_waitcnt vmcnt(0)

    v_mov_b32 v30, s46
    v_mov_b32 v31, 0
    s_mov_b64 exec, 1
    buffer_store_dword v30, v31, s[16:19], s21 offen sc0 sc1
    s_mov_b64 exec, -1

F_J1B:
    s_add_u32 m0, s57, 65536
    s_add_u32 s25, s62, 0
    buffer_load_dwordx4 v1, s[16:19], s25 offen sc0 sc1 lds
    s_add_u32 m0, s57, 98304
    s_add_u32 s25, s63, 0
    buffer_load_dwordx4 v1, s[16:19], s25 offen sc0 sc1 lds
    s_add_u32 m0, s57, 81920
    s_add_u32 s25, s62, 16384
    buffer_load_dwordx4 v1, s[16:19], s25 offen sc0 sc1 lds
    s_add_u32 m0, s57, 114688
    s_add_u32 s25, s63, 16384
    buffer_load_dwordx4 v1, s[16:19], s25 offen sc0 sc1 lds
    s_add_u32 m0, s57, 69632
    s_add_u32 s25, s62, 4096
    buffer_load_dwordx4 v1, s[16:19], s25 offen sc0 sc1 lds
    s_add_u32 m0, s57, 102400
    s_add_u32 s25, s63, 4096
    buffer_load_dwordx4 v1, s[16:19], s25 offen sc0 sc1 lds
    s_branch F_JEND
F_J2:
    v_and_b32 v28, 31, v0
    v_cmp_eq_u32 vcc, 16, v28
    v_mov_b32 v28, 0x3f803f80
    s_nop 0
    v_cndmask_b32 v212, 0, v28, vcc
    v_cndmask_b32 v213, 0, v28, vcc
    v_cndmask_b32 v214, 0, v28, vcc
    v_cndmask_b32 v215, 0, v28, vcc
    v_mov_b32 v208, 0
    v_mov_b32 v209, 0
    v_mov_b32 v210, 0
    v_mov_b32 v211, 0
    s_cmp_eq_u32 s48, 0
    s_cbranch_scc1 HP_9
    s_lshl_b32 s23, s47, 5
    s_add_u32 s23, s23, s48
    s_sub_u32 s23, s23, 1
    s_lshl_b32 s23, s23, 1
    s_lshr_b32 s24, s20, 1
    s_add_u32 s23, s23, s24
    s_lshl_b32 s23, s23, 2
    s_add_u32 s23, s23, 18878464

    v_mov_b32 v26, 0
    s_mov_b32 s56, 0
POLL_10:
    buffer_load_dword v27, v26, s[16:19], s23 offen sc0 sc1
    s_add_u32 s56, s56, 1
    s_cmp_gt_u32 s56, 200000
    s_cbranch_scc1 POLLE_11
    s_waitcnt vmcnt(0)
    v_cmp_ne_u32 vcc, s46, v27
    s_nop 4
    s_cbranch_vccnz POLL_10
POLLE_11:
    s_waitcnt vmcnt(0)

    s_lshl_b32 s23, s47, 2
    s_add_u32 s23, s23, s20
    s_lshl_b32 s23, s23, 16
    s_lshl_b32 s24, s48, 1
    s_sub_u32 s24, s24, 1
    s_lshl_b32 s24, s24, 10
    s_add_u32 s23, s23, s24
    s_add_u32 s24, s23, 9437184
    buffer_load_dwordx4 v[208:211], v1, s[16:19], s24 offen sc0 sc1
    s_add_u32 s24, s23, 11534848
    s_mov_b64 exec, s[54:55]
    buffer_load_dwordx4 v[212:215], v25, s[16:19], s24 offen sc0 sc1
    s_mov_b64 exec, -1
HP_9:

    s_add_u32 m0, s57, 86016
    s_add_u32 s25, s62, 20480
    buffer_load_dwordx4 v1, s[16:19], s25 offen sc0 sc1 lds
    s_add_u32 m0, s57, 118784
    s_add_u32 s25, s63, 20480
    buffer_load_dwordx4 v1, s[16:19], s25 offen sc0 sc1 lds
    s_add_u32 m0, s57, 73728
    s_add_u32 s25, s62, 8192
    buffer_load_dwordx4 v1, s[16:19], s25 offen sc0 sc1 lds
    s_add_u32 m0, s57, 106496
    s_add_u32 s25, s63, 8192
    buffer_load_dwordx4 v1, s[16:19], s25 offen sc0 sc1 lds
    s_add_u32 m0, s57, 90112
    s_add_u32 s25, s62, 24576
    buffer_load_dwordx4 v1, s[16:19], s25 offen sc0 sc1 lds
    s_add_u32 m0, s57, 122880
    s_add_u32 s25, s63, 24576
    buffer_load_dwordx4 v1, s[16:19], s25 offen sc0 sc1 lds
    s_branch F_JEND
F_J3:
    s_add_u32 m0, s57, 77824
    s_add_u32 s25, s62, 12288
    buffer_load_dwordx4 v1, s[16:19], s25 offen sc0 sc1 lds
    s_add_u32 m0, s57, 110592
    s_add_u32 s25, s63, 12288
    buffer_load_dwordx4 v1, s[16:19], s25 offen sc0 sc1 lds
    s_add_u32 m0, s57, 94208
    s_add_u32 s25, s62, 28672
    buffer_load_dwordx4 v1, s[16:19], s25 offen sc0 sc1 lds
    s_add_u32 m0, s57, 126976
    s_add_u32 s25, s63, 28672
    buffer_load_dwordx4 v1, s[16:19], s25 offen sc0 sc1 lds
    v_lshrrev_b32 v26, 3, v0
    s_lshl_b32 s21, s20, 3
    v_add_u32 v26, s21, v26
    v_lshlrev_b32 v26, 10, v26
    s_lshl_b32 s21, s53, 7
    v_add_u32 v26, s21, v26
    v_and_b32 v27, 7, v0
    v_lshrrev_b32 v27, 2, v27
    v_bfe_u32 v28, v0, 4, 1
    v_xor_b32 v27, v27, v28
    v_lshlrev_b32 v27, 6, v27
    v_add_u32 v26, v26, v27
    v_and_b32 v27, 3, v0
    v_lshlrev_b32 v27, 4, v27
    v_add_u32 v29, v26, v27

    s_branch F_JEND
F_J5:
    s_add_u32 m0, s57, 0
    s_mov_b32 s25, 0
    buffer_load_dwordx4 v29, s[8:11], s25 offen lds
    s_add_u32 m0, s57, 4096
    s_mov_b32 s25, 32768
    buffer_load_dwordx4 v29, s[8:11], s25 offen lds
    s_add_u32 m0, s57, 8192
    s_mov_b32 s25, 65536
    buffer_load_dwordx4 v29, s[8:11], s25 offen lds
    s_add_u32 m0, s57, 12288
    s_mov_b32 s25, 98304
    buffer_load_dwordx4 v29, s[8:11], s25 offen lds
    s_add_u32 m0, s57, 16384
    s_mov_b32 s25, 131072
    buffer_load_dwordx4 v29, s[8:11], s25 offen lds
    s_add_u32 m0, s57, 20480
    s_mov_b32 s25, 163840
    buffer_load_dwordx4 v29, s[8:11], s25 offen lds
    s_add_u32 m0, s57, 24576
    s_mov_b32 s25, 196608
    buffer_load_dwordx4 v29, s[8:11], s25 offen lds
    s_add_u32 m0, s57, 28672
    s_mov_b32 s25, 229376
    buffer_load_dwordx4 v29, s[8:11], s25 offen lds
    s_branch F_JEND
F_J6:
    s_add_u32 m0, s57, 32768
    s_mov_b32 s25, 262144
    buffer_load_dwordx4 v29, s[8:11], s25 offen lds
    s_add_u32 m0, s57, 36864
    s_mov_b32 s25, 294912
    buffer_load_dwordx4 v29, s[8:11], s25 offen lds
    s_add_u32 m0, s57, 40960
    s_mov_b32 s25, 327680
    buffer_load_dwordx4 v29, s[8:11], s25 offen lds
    s_add_u32 m0, s57, 45056
    s_mov_b32 s25, 360448
    buffer_load_dwordx4 v29, s[8:11], s25 offen lds
    s_add_u32 m0, s57, 49152
    s_mov_b32 s25, 393216
    buffer_load_dwordx4 v29, s[8:11], s25 offen lds
    s_add_u32 m0, s57, 53248
    s_mov_b32 s25, 425984
    buffer_load_dwordx4 v29, s[8:11], s25 offen lds
    s_add_u32 m0, s57, 57344
    s_mov_b32 s25, 458752
    buffer_load_dwordx4 v29, s[8:11], s25 offen lds
    s_add_u32 m0, s57, 61440
    s_mov_b32 s25, 491520
    buffer_load_dwordx4 v29, s[8:11], s25 offen lds
    s_branch F_JEND
F_J7:
    s_lshl_b32 s22, s52, 8
    s_add_u32 s22, s22, 18890752
    v_lshlrev_b32 v30, 2, v0
    s_mov_b32 s56, 0
POLL_12:
    buffer_load_dword v31, v30, s[16:19], s22 offen sc0 sc1
    s_add_u32 s56, s56, 1
    s_cmp_gt_u32 s56, 200000
    s_cbranch_scc1 POLLE_13
    s_waitcnt vmcnt(0)
    v_cmp_ne_u32 vcc, s46, v31
    s_nop 4
    s_cbranch_vccnz POLL_12
POLLE_13:
    s_waitcnt vmcnt(0)

    s_lshl_b32 s22, s52, 8
    s_add_u32 s22, s22, 18898944
    v_lshlrev_b32 v30, 2, v0
    s_mov_b32 s56, 0
POLL_14:
    buffer_load_dword v31, v30, s[16:19], s22 offen sc0 sc1
    s_add_u32 s56, s56, 1
    s_cmp_gt_u32 s56, 200000
    s_cbranch_scc1 POLLE_15
    s_waitcnt vmcnt(0)
    v_cmp_ne_u32 vcc, s46, v31
    s_nop 4
    s_cbranch_vccnz POLL_14
POLLE_15:
    s_waitcnt vmcnt(0)

    s_and_b32 s21, s20, 1
    s_lshl_b32 s23, s52, 1
    s_add_u32 s23, s23, s21
    s_lshl_b32 s22, s23, 15
    s_add_u32 s22, s22, 16777216

    buffer_load_dwordx4 v[128:131], v1, s[16:19], s22 offen offset:0 sc0 sc1
    buffer_load_dwordx4 v[132:135], v1, s[16:19], s22 offen offset:1024 sc0 sc1
    buffer_load_dwordx4 v[136:139], v1, s[16:19], s22 offen offset:2048 sc0 sc1
    buffer_load_dwordx4 v[140:143], v1, s[16:19], s22 offen offset:3072 sc0 sc1
    s_add_u32 s22, s22, 4096
    buffer_load_dwordx4 v[144:147], v1, s[16:19], s22 offen offset:0 sc0 sc1
    buffer_load_dwordx4 v[148:151], v1, s[16:19], s22 offen offset:1024 sc0 sc1
    buffer_load_dwordx4 v[152:155], v1, s[16:19], s22 offen offset:2048 sc0 sc1
    buffer_load_dwordx4 v[156:159], v1, s[16:19], s22 offen offset:3072 sc0 sc1
    s_add_u32 s22, s22, 4096
    buffer_load_dwordx4 v[160:163], v1, s[16:19], s22 offen offset:0 sc0 sc1
    buffer_load_dwordx4 v[164:167], v1, s[16:19], s22 offen offset:1024 sc0 sc1
    buffer_load_dwordx4 v[168:171], v1, s[16:19], s22 offen offset:2048 sc0 sc1
    buffer_load_dwordx4 v[172:175], v1, s[16:19], s22 offen offset:3072 sc0 sc1
    s_add_u32 s22, s22, 4096
    buffer_load_dwordx4 v[176:179], v1, s[16:19], s22 offen offset:0 sc0 sc1
    buffer_load_dwordx4 v[180:183], v1, s[16:19], s22 offen offset:1024 sc0 sc1
    buffer_load_dwordx4 v[184:187], v1, s[16:19], s22 offen offset:2048 sc0 sc1
    buffer_load_dwordx4 v[188:191], v1, s[16:19], s22 offen offset:3072 sc0 sc1
    s_branch F_JEND
F_J8:
    s_and_b32 s21, s20, 1
    s_lshl_b32 s23, s52, 1
    s_add_u32 s23, s23, s21
    s_lshl_b32 s22, s23, 15
    s_add_u32 s22, s22, 16793600

    buffer_load_dwordx4 v[192:195], v1, s[16:19], s22 offen offset:0 sc0 sc1
    buffer_load_dwordx4 v[196:199], v1, s[16:19], s22 offen offset:1024 sc0 sc1
    buffer_load_dwordx4 v[200:203], v1, s[16:19], s22 offen offset:2048 sc0 sc1
    buffer_load_dwordx4 v[204:207], v1, s[16:19], s22 offen offset:3072 sc0 sc1
    s_add_u32 s22, s22, 4096
    buffer_load_dwordx4 v[208:211], v1, s[16:19], s22 offen offset:0 sc0 sc1
    buffer_load_dwordx4 v[212:215], v1, s[16:19], s22 offen offset:1024 sc0 sc1
    buffer_load_dwordx4 v[216:219], v1, s[16:19], s22 offen offset:2048 sc0 sc1
    buffer_load_dwordx4 v[220:223], v1, s[16:19], s22 offen offset:3072 sc0 sc1
    s_add_u32 s22, s22, 4096
    buffer_load_dwordx4 v[224:227], v1, s[16:19], s22 offen offset:0 sc0 sc1
    buffer_load_dwordx4 v[228:231], v1, s[16:19], s22 offen offset:1024 sc0 sc1
    buffer_load_dwordx4 v[232:235], v1, s[16:19], s22 offen offset:2048 sc0 sc1
    buffer_load_dwordx4 v[236:239], v1, s[16:19], s22 offen offset:3072 sc0 sc1
    s_add_u32 s22, s22, 4096
    buffer_load_dwordx4 v[240:243], v1, s[16:19], s22 offen offset:0 sc0 sc1
    buffer_load_dwordx4 v[244:247], v1, s[16:19], s22 offen offset:1024 sc0 sc1
    buffer_load_dwordx4 v[248:251], v1, s[16:19], s22 offen offset:2048 sc0 sc1
    buffer_load_dwordx4 v[252:255], v1, s[16:19], s22 offen offset:3072 sc0 sc1
    s_branch F_JEND
F_ATT_END:
    s_cmp_eq_u32 s59, 0
    s_cbranch_scc0 F_COMB

    s_lshl_b32 s21, s20, 2
    s_add_u32 s21, s21, 155648
    v_mov_b32 v26, s21
    v_mov_b32 v27, s46
    ds_write_b32 v26, v27
    s_and_b32 s21, s20, 1
    s_lshl_b32 s23, s52, 1
    s_add_u32 s23, s23, s21

    v_lshrrev_b32 v4, 5, v0
    v_lshlrev_b32 v4, 2, v4
    v_bfe_u32 v5, v0, 2, 2
    v_add_u32 v4, v4, v5
    v_lshlrev_b32 v4, 7, v4
    v_lshrrev_b32 v5, 1, v5
    s_lshr_b32 s21, s20, 1
    v_xor_b32 v5, s21, v5
    v_lshlrev_b32 v5, 6, v5
    v_add_u32 v4, v4, v5
    v_and_b32 v5, 1, v0
    v_lshlrev_b32 v5, 5, v5
    v_add_u32 v4, v4, v5
    v_bfe_u32 v5, v0, 4, 1
    v_lshlrev_b32 v5, 4, v5
    v_add_u32 v4, v4, v5
    v_bfe_u32 v5, v0, 1, 1
    v_lshlrev_b32 v5, 3, v5
    v_add_u32 v6, v4, v5
    s_lshl_b32 s23, s23, 5
    v_and_b32 v4, 31, v0
    v_add_u32 v4, s23, v4
    v_lshlrev_b32 v4, 11, v4
    v_lshrrev_b32 v5, 5, v0
    v_lshlrev_b32 v5, 5, v5
    v_add_u32 v7, v4, v5
    s_lshl_b32 s23, s53, 7
    s_lshl_b32 s21, s21, 6
    s_add_u32 s23, s23, s21
    s_add_u32 s23, s23, 1024
    s_mov_b32 s56, 0
    v_and_b32 v26, 3, v0
    v_lshlrev_b32 v26, 2, v26
    v_add_u32 v26, 155648, v26
F_CSPIN:
    ds_read_b32 v27, v26
    s_add_u32 s56, s56, 1
    s_cmp_gt_u32 s56, 200000
    s_cbranch_scc1 F_CSPINE
    s_waitcnt lgkmcnt(0)
    v_cmp_ne_u32 vcc, s46, v27
    s_nop 4
    s_cbranch_vccnz F_CSPIN
F_CSPINE:
    s_waitcnt lgkmcnt(0)

    ds_read_b64_tr_b16 v[64:65], v6 offset:0
    ds_read_b64_tr_b16 v[66:67], v6 offset:1024
    ds_read_b64_tr_b16 v[68:69], v6 offset:2048
    ds_read_b64_tr_b16 v[70:71], v6 offset:3072
    ds_read_b64_tr_b16 v[72:73], v6 offset:4096
    ds_read_b64_tr_b16 v[74:75], v6 offset:5120
    ds_read_b64_tr_b16 v[76:77], v6 offset:6144
    ds_read_b64_tr_b16 v[78:79], v6 offset:7168
    s_waitcnt vmcnt(31) lgkmcnt(6)
    v_mfma_f32_32x32x16_bf16 v[48:63], v[64:67], v[128:131], 0
    ds_read_b64_tr_b16 v[64:65], v6 offset:8192
    ds_read_b64_tr_b16 v[66:67], v6 offset:9216
    s_waitcnt vmcnt(30) lgkmcnt(6)
    v_mfma_f32_32x32x16_bf16 v[48:63], v[68:71], v[132:135], v[48:63]
    ds_read_b64_tr_b16 v[68:69], v6 offset:10240
    ds_read_b64_tr_b16 v[70:71], v6 offset:11264
    s_waitcnt vmcnt(29) lgkmcnt(6)
    v_mfma_f32_32x32x16_bf16 v[48:63], v[72:75], v[136:139], v[48:63]
    ds_read_b64_tr_b16 v[72:73], v6 offset:12288
    ds_read_b64_tr_b16 v[74:75], v6 offset:13312
    s_waitcnt vmcnt(28) lgkmcnt(6)
    v_mfma_f32_32x32x16_bf16 v[48:63], v[76:79], v[140:143], v[48:63]
    ds_read_b64_tr_b16 v[76:77], v6 offset:14336
    ds_read_b64_tr_b16 v[78:79], v6 offset:15360
    s_waitcnt vmcnt(27) lgkmcnt(6)
    v_mfma_f32_32x32x16_bf16 v[48:63], v[64:67], v[144:147], v[48:63]
    ds_read_b64_tr_b16 v[64:65], v6 offset:16384
    ds_read_b64_tr_b16 v[66:67], v6 offset:17408
    s_waitcnt vmcnt(26) lgkmcnt(6)
    v_mfma_f32_32x32x16_bf16 v[48:63], v[68:71], v[148:151], v[48:63]
    ds_read_b64_tr_b16 v[68:69], v6 offset:18432
    ds_read_b64_tr_b16 v[70:71], v6 offset:19456
    s_waitcnt vmcnt(25) lgkmcnt(6)
    v_mfma_f32_32x32x16_bf16 v[48:63], v[72:75], v[152:155], v[48:63]
    ds_read_b64_tr_b16 v[72:73], v6 offset:20480
    ds_read_b64_tr_b16 v[74:75], v6 offset:21504
    s_waitcnt vmcnt(24) lgkmcnt(6)
    v_mfma_f32_32x32x16_bf16 v[48:63], v[76:79], v[156:159], v[48:63]
    ds_read_b64_tr_b16 v[76:77], v6 offset:22528
    ds_read_b64_tr_b16 v[78:79], v6 offset:23552
    s_waitcnt vmcnt(23) lgkmcnt(6)
    v_mfma_f32_32x32x16_bf16 v[48:63], v[64:67], v[160:163], v[48:63]
    ds_read_b64_tr_b16 v[64:65], v6 offset:24576
    ds_read_b64_tr_b16 v[66:67], v6 offset:25600
    s_waitcnt vmcnt(22) lgkmcnt(6)
    v_mfma_f32_32x32x16_bf16 v[48:63], v[68:71], v[164:167], v[48:63]
    ds_read_b64_tr_b16 v[68:69], v6 offset:26624
    ds_read_b64_tr_b16 v[70:71], v6 offset:27648
    s_waitcnt vmcnt(21) lgkmcnt(6)
    v_mfma_f32_32x32x16_bf16 v[48:63], v[72:75], v[168:171], v[48:63]
    ds_read_b64_tr_b16 v[72:73], v6 offset:28672
    ds_read_b64_tr_b16 v[74:75], v6 offset:29696
    s_waitcnt vmcnt(20) lgkmcnt(6)
    v_mfma_f32_32x32x16_bf16 v[48:63], v[76:79], v[172:175], v[48:63]
    ds_read_b64_tr_b16 v[76:77], v6 offset:30720
    ds_read_b64_tr_b16 v[78:79], v6 offset:31744
    s_waitcnt vmcnt(19) lgkmcnt(6)
    v_mfma_f32_32x32x16_bf16 v[48:63], v[64:67], v[176:179], v[48:63]
    ds_read_b64_tr_b16 v[64:65], v6 offset:32768
    ds_read_b64_tr_b16 v[66:67], v6 offset:33792
    s_waitcnt vmcnt(18) lgkmcnt(6)
    v_mfma_f32_32x32x16_bf16 v[48:63], v[68:71], v[180:183], v[48:63]
    ds_read_b64_tr_b16 v[68:69], v6 offset:34816
    ds_read_b64_tr_b16 v[70:71], v6 offset:35840
    s_waitcnt vmcnt(17) lgkmcnt(6)
    v_mfma_f32_32x32x16_bf16 v[48:63], v[72:75], v[184:187], v[48:63]
    ds_read_b64_tr_b16 v[72:73], v6 offset:36864
    ds_read_b64_tr_b16 v[74:75], v6 offset:37888
    s_waitcnt vmcnt(16) lgkmcnt(6)
    v_mfma_f32_32x32x16_bf16 v[48:63], v[76:79], v[188:191], v[48:63]
    ds_read_b64_tr_b16 v[76:77], v6 offset:38912
    ds_read_b64_tr_b16 v[78:79], v6 offset:39936
    s_waitcnt vmcnt(15) lgkmcnt(6)
    v_mfma_f32_32x32x16_bf16 v[48:63], v[64:67], v[192:195], v[48:63]
    ds_read_b64_tr_b16 v[64:65], v6 offset:40960
    ds_read_b64_tr_b16 v[66:67], v6 offset:41984
    s_waitcnt vmcnt(14) lgkmcnt(6)
    v_mfma_f32_32x32x16_bf16 v[48:63], v[68:71], v[196:199], v[48:63]
    ds_read_b64_tr_b16 v[68:69], v6 offset:43008
    ds_read_b64_tr_b16 v[70:71], v6 offset:44032
    s_waitcnt vmcnt(13) lgkmcnt(6)
    v_mfma_f32_32x32x16_bf16 v[48:63], v[72:75], v[200:203], v[48:63]
    ds_read_b64_tr_b16 v[72:73], v6 offset:45056
    ds_read_b64_tr_b16 v[74:75], v6 offset:46080
    s_waitcnt vmcnt(12) lgkmcnt(6)
    v_mfma_f32_32x32x16_bf16 v[48:63], v[76:79], v[204:207], v[48:63]
    ds_read_b64_tr_b16 v[76:77], v6 offset:47104
    ds_read_b64_tr_b16 v[78:79], v6 offset:48128
    s_waitcnt vmcnt(11) lgkmcnt(6)
    v_mfma_f32_32x32x16_bf16 v[48:63], v[64:67], v[208:211], v[48:63]
    ds_read_b64_tr_b16 v[64:65], v6 offset:49152
    ds_read_b64_tr_b16 v[66:67], v6 offset:50176
    s_waitcnt vmcnt(10) lgkmcnt(6)
    v_mfma_f32_32x32x16_bf16 v[48:63], v[68:71], v[212:215], v[48:63]
    ds_read_b64_tr_b16 v[68:69], v6 offset:51200
    ds_read_b64_tr_b16 v[70:71], v6 offset:52224
    s_waitcnt vmcnt(9) lgkmcnt(6)
    v_mfma_f32_32x32x16_bf16 v[48:63], v[72:75], v[216:219], v[48:63]
    ds_read_b64_tr_b16 v[72:73], v6 offset:53248
    ds_read_b64_tr_b16 v[74:75], v6 offset:54272
    s_waitcnt vmcnt(8) lgkmcnt(6)
    v_mfma_f32_32x32x16_bf16 v[48:63], v[76:79], v[220:223], v[48:63]
    ds_read_b64_tr_b16 v[76:77], v6 offset:55296
    ds_read_b64_tr_b16 v[78:79], v6 offset:56320
    s_waitcnt vmcnt(7) lgkmcnt(6)
    v_mfma_f32_32x32x16_bf16 v[48:63], v[64:67], v[224:227], v[48:63]
    ds_read_b64_tr_b16 v[64:65], v6 offset:57344
    ds_read_b64_tr_b16 v[66:67], v6 offset:58368
    s_waitcnt vmcnt(6) lgkmcnt(6)
    v_mfma_f32_32x32x16_bf16 v[48:63], v[68:71], v[228:231], v[48:63]
    ds_read_b64_tr_b16 v[68:69], v6 offset:59392
    ds_read_b64_tr_b16 v[70:71], v6 offset:60416
    s_waitcnt vmcnt(5) lgkmcnt(6)
    v_mfma_f32_32x32x16_bf16 v[48:63], v[72:75], v[232:235], v[48:63]
    ds_read_b64_tr_b16 v[72:73], v6 offset:61440
    ds_read_b64_tr_b16 v[74:75], v6 offset:62464
    s_waitcnt vmcnt(4) lgkmcnt(6)
    v_mfma_f32_32x32x16_bf16 v[48:63], v[76:79], v[236:239], v[48:63]
    ds_read_b64_tr_b16 v[76:77], v6 offset:63488
    ds_read_b64_tr_b16 v[78:79], v6 offset:64512
    s_waitcnt vmcnt(3) lgkmcnt(6)
    v_mfma_f32_32x32x16_bf16 v[48:63], v[64:67], v[240:243], v[48:63]
    s_waitcnt vmcnt(2) lgkmcnt(4)
    v_mfma_f32_32x32x16_bf16 v[48:63], v[68:71], v[244:247], v[48:63]
    s_waitcnt vmcnt(1) lgkmcnt(2)
    v_mfma_f32_32x32x16_bf16 v[48:63], v[72:75], v[248:251], v[48:63]
    s_waitcnt vmcnt(0) lgkmcnt(0)
    v_mfma_f32_32x32x16_bf16 v[48:63], v[76:79], v[252:255], v[48:63]
    s_mov_b32 s24, s36
    s_and_b32 s25, s37, 0xffff
    s_mov_b32 s26, 0x400000
    s_mov_b32 s27, 0x00020000
    s_nop 10
    v_cvt_pk_bf16_f32 v64, v48, v49
    v_cvt_pk_bf16_f32 v65, v50, v51
    v_cvt_pk_bf16_f32 v66, v52, v53
    v_cvt_pk_bf16_f32 v67, v54, v55
    v_cvt_pk_bf16_f32 v68, v56, v57
    v_cvt_pk_bf16_f32 v69, v58, v59
    v_cvt_pk_bf16_f32 v70, v60, v61
    v_cvt_pk_bf16_f32 v71, v62, v63
    buffer_store_dwordx4 v[64:67], v7, s[24:27], s23 offen sc0 sc1
    buffer_store_dwordx4 v[68:71], v7, s[24:27], s23 offen offset:16 sc0 sc1
F_COMB:
    s_mul_i32 s21, s20, 2304
    s_add_u32 s21, s21, 131072
    v_lshlrev_b32 v27, 2, v0
    v_add_u32 v26, s21, v27
    s_xor_b32 s22, s20, 4
    s_mul_i32 s22, s22, 2304
    s_add_u32 s22, s22, 131072
    v_add_u32 v27, s22, v27
    s_nop 7
    s_cmp_eq_u32 s59, 0
    s_cbranch_scc1 F_G0

    ds_write_b32 v26, v80 offset:0
    ds_write_b32 v26, v81 offset:256
    ds_write_b32 v26, v82 offset:512
    ds_write_b32 v26, v83 offset:768
    ds_write_b32 v26, v84 offset:1024
    ds_write_b32 v26, v85 offset:1280
    ds_write_b32 v26, v86 offset:1536
    ds_write_b32 v26, v87 offset:1792
    ds_write_b32 v26, v88 offset:2048
    s_waitcnt lgkmcnt(0)
    v_mov_b32 v80, v112
    v_mov_b32 v81, v113
    v_mov_b32 v82, v114
    v_mov_b32 v83, v115
    v_mov_b32 v84, v116
    v_mov_b32 v85, v117
    v_mov_b32 v86, v118
    v_mov_b32 v87, v119
    v_mov_b32 v88, v120
    s_branch F_G1
F_G0:
    ds_write_b32 v26, v112 offset:0
    ds_write_b32 v26, v113 offset:256
    ds_write_b32 v26, v114 offset:512
    ds_write_b32 v26, v115 offset:768
    ds_write_b32 v26, v116 offset:1024
    ds_write_b32 v26, v117 offset:1280
    ds_write_b32 v26, v118 offset:1536
    ds_write_b32 v26, v119 offset:1792
    ds_write_b32 v26, v120 offset:2048
F_G1:
    s_waitcnt lgkmcnt(0)
    s_barrier
    ds_read_b32 v112, v27 offset:0
    ds_read_b32 v113, v27 offset:256
    ds_read_b32 v114, v27 offset:512
    ds_read_b32 v115, v27 offset:768
    ds_read_b32 v116, v27 offset:1024
    ds_read_b32 v117, v27 offset:1280
    ds_read_b32 v118, v27 offset:1536
    ds_read_b32 v119, v27 offset:1792
    ds_read_b32 v120, v27 offset:2048
    s_add_u32 s60, s60, s59
    s_lshl_b32 s21, s60, 5
    s_add_u32 s21, s21, s50
    s_lshl_b32 s21, s21, 10
    s_add_u32 s61, s21, 14680064
    s_waitcnt lgkmcnt(0)

    v_add_f32 v80, v80, v112
    v_add_f32 v81, v81, v113
    v_add_f32 v82, v82, v114
    v_add_f32 v83, v83, v115
    v_add_f32 v84, v84, v116
    v_add_f32 v85, v85, v117
    v_add_f32 v86, v86, v118
    v_add_f32 v87, v87, v119
    v_add_f32 v88, v88, v120
    v_mov_b32 v26, v88
    v_mov_b32 v27, v88
    v_and_b32 v28, 0x7fffffff, v80
    v_and_b32 v30, 0x7fffffff, v81
    v_permlane32_swap_b32 v26, v27
    v_max_u32 v28, v28, v30

    v_and_b32 v30, 0x7fffffff, v82
    v_max_u32 v28, v28, v30
    v_and_b32 v30, 0x7fffffff, v83
    v_max_u32 v28, v28, v30
    v_and_b32 v30, 0x7fffffff, v84
    v_max_u32 v28, v28, v30
    v_and_b32 v30, 0x7fffffff, v85
    v_max_u32 v28, v28, v30
    v_and_b32 v30, 0x7fffffff, v86
    v_max_u32 v28, v28, v30
    v_and_b32 v30, 0x7fffffff, v87
    v_max_u32 v28, v28, v30
    v_and_b32 v30, 0x7fffffff, v26
    v_max_u32 v28, v28, v30
    v_mov_b32 v30, 0x7b800000
    v_cmp_le_u32 vcc, v30, v28
    v_mov_b32 v30, 0x21800000
    s_mov_b64 s[22:23], vcc
    v_cmp_gt_u32 vcc, v30, v26
    s_nop 1
    s_or_b64 vcc, vcc, s[22:23]
    s_nop 4
    s_cbranch_vccnz F_FALLBACK
F_FB_RET:

    v_mov_b32 v26, v88
    v_mov_b32 v27, v88
    s_nop 1
    v_permlane32_swap_b32 v26, v27
    s_nop 1
    v_rcp_f32 v26, v26
    s_nop 0

    v_mul_f32 v80, v80, v26
    v_mul_f32 v81, v81, v26
    v_mul_f32 v82, v82, v26
    v_mul_f32 v83, v83, v26
    v_mul_f32 v84, v84, v26
    v_mul_f32 v85, v85, v26
    v_mul_f32 v86, v86, v26
    v_mul_f32 v87, v87, v26
    v_cvt_pk_bf16_f32 v88, v80, v81
    v_cvt_pk_bf16_f32 v89, v82, v83
    v_cvt_pk_bf16_f32 v90, v84, v85
    v_cvt_pk_bf16_f32 v91, v86, v87
    buffer_store_dwordx4 v[88:91], v1, s[16:19], s61 offen sc0 sc1
    v_lshrrev_b32 v26, 3, v0
    s_lshl_b32 s21, s20, 3
    v_add_u32 v26, s21, v26
    v_lshlrev_b32 v26, 10, v26
    s_lshl_b32 s21, s53, 7
    v_add_u32 v26, s21, v26
    v_and_b32 v27, 7, v0
    v_lshrrev_b32 v27, 2, v27
    v_bfe_u32 v28, v0, 4, 1
    v_xor_b32 v27, v27, v28
    v_lshlrev_b32 v27, 6, v27
    v_add_u32 v26, v26, v27
    v_and_b32 v27, 3, v0
    v_lshlrev_b32 v27, 4, v27
    v_add_u32 v29, v26, v27
    s_lshl_b32 s57, s20, 10

    s_add_u32 m0, s57, 0
    s_mov_b32 s25, 0
    buffer_load_dwordx4 v29, s[12:15], s25 offen lds
    s_add_u32 m0, s57, 8192
    s_mov_b32 s25, 65536
    buffer_load_dwordx4 v29, s[12:15], s25 offen lds
    s_add_u32 m0, s57, 16384
    s_mov_b32 s25, 131072
    buffer_load_dwordx4 v29, s[12:15], s25 offen lds
    s_add_u32 m0, s57, 24576
    s_mov_b32 s25, 196608
    buffer_load_dwordx4 v29, s[12:15], s25 offen lds
    s_add_u32 m0, s57, 32768
    s_mov_b32 s25, 262144
    buffer_load_dwordx4 v29, s[12:15], s25 offen lds
    s_add_u32 m0, s57, 40960
    s_mov_b32 s25, 327680
    buffer_load_dwordx4 v29, s[12:15], s25 offen lds
    s_add_u32 m0, s57, 49152
    s_mov_b32 s25, 393216
    buffer_load_dwordx4 v29, s[12:15], s25 offen lds
    s_add_u32 m0, s57, 57344
    s_mov_b32 s25, 458752
    buffer_load_dwordx4 v29, s[12:15], s25 offen lds
    v_lshrrev_b32 v26, 5, v0
    v_lshlrev_b32 v26, 2, v26
    v_bfe_u32 v27, v0, 2, 2
    v_add_u32 v26, v26, v27
    v_lshlrev_b32 v26, 7, v26
    v_lshrrev_b32 v27, 1, v27
    v_lshlrev_b32 v27, 6, v27
    v_add_u32 v26, v26, v27
    v_and_b32 v27, 1, v0
    v_lshlrev_b32 v27, 5, v27
    v_add_u32 v26, v26, v27
    v_bfe_u32 v27, v0, 4, 1
    v_lshlrev_b32 v27, 4, v27
    v_add_u32 v26, v26, v27
    v_bfe_u32 v27, v0, 1, 1
    v_lshlrev_b32 v27, 3, v27
    v_add_u32 v26, v26, v27
    s_lshr_b32 s22, s20, 1
    s_lshl_b32 s22, s22, 14
    v_add_u32 v4, s22, v26
    v_xor_b32 v5, 64, v4
    s_lshl_b32 s21, s20, 13
    s_add_u32 s21, s21, 65536
    v_add_u32 v6, s21, v1
    s_and_b32 s21, s20, 1
    s_lshl_b32 s21, s21, 13
    s_bfe_u32 s22, s20, 0x10001
    s_lshl_b32 s22, s22, 12
    s_add_u32 s21, s21, s22
    s_lshr_b32 s22, s20, 2
    s_lshl_b32 s22, s22, 11
    s_add_u32 s21, s21, s22
    s_add_u32 s21, s21, 65536
    v_add_u32 v7, s21, v1
    s_lshl_b32 s21, s52, 6
    s_and_b32 s22, s20, 1
    s_lshl_b32 s22, s22, 5
    s_add_u32 s21, s21, s22
    v_and_b32 v26, 31, v0
    v_add_u32 v26, s21, v26
    v_lshlrev_b32 v26, 11, v26
    v_lshrrev_b32 v27, 5, v0
    v_lshlrev_b32 v27, 5, v27
    v_add_u32 v8, v26, v27
    s_lshl_b32 s63, s53, 7
    s_bfe_u32 s22, s20, 0x10001
    s_lshl_b32 s22, s22, 6
    s_add_u32 s63, s63, s22
    s_lshr_b32 s22, s20, 2
    s_lshl_b32 s22, s22, 4
    s_add_u32 s63, s63, s22
    s_and_b32 s21, s20, 1
    s_lshr_b32 s22, s20, 1
    s_lshl_b32 s23, s52, 1
    s_add_u32 s23, s23, s21
    s_lshl_b32 s23, s23, 15
    s_lshl_b32 s24, s22, 13
    s_add_u32 s62, s23, s24

    s_mov_b32 s24, s36
    s_and_b32 s25, s37, 0xffff
    s_mov_b32 s26, 0x400000
    s_mov_b32 s27, 0x00020000
    s_waitcnt vmcnt(0)
    s_barrier
    ds_read_b64_tr_b16 v[64:65], v4 offset:0
    ds_read_b64_tr_b16 v[66:67], v4 offset:1024
    ds_read_b64_tr_b16 v[68:69], v5 offset:0
    ds_read_b64_tr_b16 v[70:71], v5 offset:1024
    ds_read_b64_tr_b16 v[72:73], v4 offset:2048
    ds_read_b64_tr_b16 v[74:75], v4 offset:3072
    ds_read_b64_tr_b16 v[76:77], v5 offset:2048
    ds_read_b64_tr_b16 v[78:79], v5 offset:3072
    ds_read_b64_tr_b16 v[80:81], v4 offset:4096
    ds_read_b64_tr_b16 v[82:83], v4 offset:5120
    ds_read_b64_tr_b16 v[84:85], v5 offset:4096
    ds_read_b64_tr_b16 v[86:87], v5 offset:5120
    ds_read_b64_tr_b16 v[88:89], v4 offset:6144
    ds_read_b64_tr_b16 v[90:91], v4 offset:7168
    ds_read_b64_tr_b16 v[92:93], v5 offset:6144
    ds_read_b64_tr_b16 v[94:95], v5 offset:7168
    ds_read_b64_tr_b16 v[96:97], v4 offset:8192
    ds_read_b64_tr_b16 v[98:99], v4 offset:9216
    ds_read_b64_tr_b16 v[100:101], v5 offset:8192
    ds_read_b64_tr_b16 v[102:103], v5 offset:9216
    ds_read_b64_tr_b16 v[104:105], v4 offset:10240
    ds_read_b64_tr_b16 v[106:107], v4 offset:11264
    ds_read_b64_tr_b16 v[108:109], v5 offset:10240
    ds_read_b64_tr_b16 v[110:111], v5 offset:11264
    ds_read_b64_tr_b16 v[112:113], v4 offset:12288
    ds_read_b64_tr_b16 v[114:115], v4 offset:13312
    ds_read_b64_tr_b16 v[116:117], v5 offset:12288
    ds_read_b64_tr_b16 v[118:119], v5 offset:13312
    ds_read_b64_tr_b16 v[120:121], v4 offset:14336
    ds_read_b64_tr_b16 v[122:123], v4 offset:15360
    ds_read_b64_tr_b16 v[124:125], v5 offset:14336
    ds_read_b64_tr_b16 v[126:127], v5 offset:15360
    s_cmp_eq_u32 s20, 0
    s_cbranch_scc0 F_NPOA
    v_lshlrev_b32 v30, 10, v0
    s_lshl_b32 s22, s52, 16
    s_add_u32 s22, s22, 14680064
    s_mov_b32 s56, 0
F_SPOLL:
    buffer_load_dword v31, v30, s[16:19], s22 offen sc0 sc1
    s_add_u32 s56, s56, 1
    s_cmp_gt_u32 s56, 200000
    s_cbranch_scc1 F_SPOLLE
    s_waitcnt vmcnt(0)
    v_cmp_eq_u32 vcc, -1, v31
    s_nop 4
    s_cbranch_vccnz F_SPOLL
F_SPOLLE:
    s_waitcnt vmcnt(0)

F_NPOA:
    s_barrier
    s_mov_b32 s56, 0
F_OALOAD:
    s_add_u32 s21, s62, 14680064
    buffer_load_dwordx4 v[136:139], v1, s[16:19], s21 offen offset:0 sc0 sc1
    buffer_load_dwordx4 v[140:143], v1, s[16:19], s21 offen offset:1024 sc0 sc1
    buffer_load_dwordx4 v[144:147], v1, s[16:19], s21 offen offset:2048 sc0 sc1
    buffer_load_dwordx4 v[148:151], v1, s[16:19], s21 offen offset:3072 sc0 sc1
    s_add_u32 s21, s21, 4096
    buffer_load_dwordx4 v[152:155], v1, s[16:19], s21 offen offset:0 sc0 sc1
    buffer_load_dwordx4 v[156:159], v1, s[16:19], s21 offen offset:1024 sc0 sc1
    buffer_load_dwordx4 v[160:163], v1, s[16:19], s21 offen offset:2048 sc0 sc1
    buffer_load_dwordx4 v[164:167], v1, s[16:19], s21 offen offset:3072 sc0 sc1
    s_waitcnt lgkmcnt(0)
    s_mov_b64 s[22:23], 0
    s_waitcnt vmcnt(7)
    v_mfma_f32_32x32x16_bf16 v[32:47], v[64:67], v[136:139], 0
    v_mfma_f32_32x32x16_bf16 v[48:63], v[68:71], v[136:139], 0
    v_cmp_eq_u32 vcc, -1, v136
    s_nop 0
    s_or_b64 s[22:23], s[22:23], vcc
    s_waitcnt vmcnt(6)
    v_mfma_f32_32x32x16_bf16 v[32:47], v[72:75], v[140:143], v[32:47]
    v_mfma_f32_32x32x16_bf16 v[48:63], v[76:79], v[140:143], v[48:63]
    v_cmp_eq_u32 vcc, -1, v140
    s_nop 0
    s_or_b64 s[22:23], s[22:23], vcc
    s_waitcnt vmcnt(5)
    v_mfma_f32_32x32x16_bf16 v[32:47], v[80:83], v[144:147], v[32:47]
    v_mfma_f32_32x32x16_bf16 v[48:63], v[84:87], v[144:147], v[48:63]
    v_cmp_eq_u32 vcc, -1, v144
    s_nop 0
    s_or_b64 s[22:23], s[22:23], vcc
    s_waitcnt vmcnt(4)
    v_mfma_f32_32x32x16_bf16 v[32:47], v[88:91], v[148:151], v[32:47]
    v_mfma_f32_32x32x16_bf16 v[48:63], v[92:95], v[148:151], v[48:63]
    v_cmp_eq_u32 vcc, -1, v148
    s_nop 0
    s_or_b64 s[22:23], s[22:23], vcc
    s_waitcnt vmcnt(3)
    v_mfma_f32_32x32x16_bf16 v[32:47], v[96:99], v[152:155], v[32:47]
    v_mfma_f32_32x32x16_bf16 v[48:63], v[100:103], v[152:155], v[48:63]
    v_cmp_eq_u32 vcc, -1, v152
    s_nop 0
    s_or_b64 s[22:23], s[22:23], vcc
    s_waitcnt vmcnt(2)
    v_mfma_f32_32x32x16_bf16 v[32:47], v[104:107], v[156:159], v[32:47]
    v_mfma_f32_32x32x16_bf16 v[48:63], v[108:111], v[156:159], v[48:63]
    v_cmp_eq_u32 vcc, -1, v156
    s_nop 0
    s_or_b64 s[22:23], s[22:23], vcc
    s_waitcnt vmcnt(1)
    v_mfma_f32_32x32x16_bf16 v[32:47], v[112:115], v[160:163], v[32:47]
    v_mfma_f32_32x32x16_bf16 v[48:63], v[116:119], v[160:163], v[48:63]
    v_cmp_eq_u32 vcc, -1, v160
    s_nop 0
    s_or_b64 s[22:23], s[22:23], vcc
    s_waitcnt vmcnt(0)
    v_mfma_f32_32x32x16_bf16 v[32:47], v[120:123], v[164:167], v[32:47]
    v_mfma_f32_32x32x16_bf16 v[48:63], v[124:127], v[164:167], v[48:63]
    v_cmp_eq_u32 vcc, -1, v164
    s_nop 0
    s_or_b64 s[22:23], s[22:23], vcc
    s_add_u32 s56, s56, 1
    s_cmp_gt_u32 s56, 12500
    s_cbranch_scc1 F_OAOK
    s_cmp_lg_u64 s[22:23], 0
    s_cbranch_scc1 F_OALOAD
F_OAOK:

    s_nop 15
    ds_write_b128 v6, v[32:35] offset:0
    ds_write_b128 v6, v[36:39] offset:1024
    ds_write_b128 v6, v[40:43] offset:2048
    ds_write_b128 v6, v[44:47] offset:3072
    ds_write_b128 v6, v[48:51] offset:4096
    ds_write_b128 v6, v[52:55] offset:5120
    ds_write_b128 v6, v[56:59] offset:6144
    ds_write_b128 v6, v[60:63] offset:7168
    s_waitcnt lgkmcnt(0)
    s_barrier
    ds_read_b128 v[32:35], v7 offset:0
    ds_read_b128 v[36:39], v7 offset:1024
    ds_read_b128 v[40:43], v7 offset:16384
    ds_read_b128 v[44:47], v7 offset:17408
    ds_read_b128 v[48:51], v7 offset:32768
    ds_read_b128 v[52:55], v7 offset:33792
    ds_read_b128 v[56:59], v7 offset:49152
    ds_read_b128 v[60:63], v7 offset:50176
    s_waitcnt lgkmcnt(0)
    v_add_f32 v32, v32, v40
    v_add_f32 v48, v48, v56
    v_add_f32 v33, v33, v41
    v_add_f32 v49, v49, v57
    v_add_f32 v34, v34, v42
    v_add_f32 v50, v50, v58
    v_add_f32 v35, v35, v43
    v_add_f32 v51, v51, v59
    v_add_f32 v36, v36, v44
    v_add_f32 v52, v52, v60
    v_add_f32 v37, v37, v45
    v_add_f32 v53, v53, v61
    v_add_f32 v38, v38, v46
    v_add_f32 v54, v54, v62
    v_add_f32 v39, v39, v47
    v_add_f32 v55, v55, v63
    v_add_f32 v32, v32, v48
    v_add_f32 v33, v33, v49
    v_add_f32 v34, v34, v50
    v_add_f32 v35, v35, v51
    v_add_f32 v36, v36, v52
    v_add_f32 v37, v37, v53
    v_add_f32 v38, v38, v54
    v_add_f32 v39, v39, v55
    v_cvt_pk_bf16_f32 v12, v32, v33
    v_cvt_pk_bf16_f32 v13, v34, v35
    v_cvt_pk_bf16_f32 v14, v36, v37
    v_cvt_pk_bf16_f32 v15, v38, v39
    buffer_store_dwordx4 v[12:15], v8, s[24:27], s63 offen
    s_endpgm
F_FALLBACK:
    s_lshl_b32 s21, s50, 16
    s_lshl_b32 s22, s60, 10
    s_add_u32 s22, s22, s21
    s_add_u32 s22, s22, 0
    buffer_load_dwordx4 v[4:7], v1, s[16:19], s22 offen sc0 sc1
    s_add_u32 s23, s21, 2097152
    s_add_u32 s24, s21, 4194304
    v_mov_b32 v26, 0xff800000
    s_mov_b32 s22, 0
F_FB1:
    s_lshl_b32 s21, s22, 10
    s_add_u32 s21, s21, s23
    buffer_load_dwordx4 v[12:15], v1, s[16:19], s21 offen sc0 sc1
    s_waitcnt vmcnt(0)
    v_mfma_f32_32x32x16_bf16 v[48:63], v[12:15], v[4:7], 0
    s_nop 15

    v_max3_f32 v27, v48, v49, v50
    v_max3_f32 v28, v56, v57, v58
    v_max3_f32 v27, v27, v51, v52
    v_max3_f32 v28, v28, v59, v60
    v_max3_f32 v27, v27, v53, v54
    v_max3_f32 v28, v28, v61, v62
    v_max_f32 v27, v27, v55
    v_max_f32 v28, v28, v63
    v_max_f32 v27, v27, v28
    v_max_f32 v26, v26, v27
    s_add_u32 s22, s22, 1
    s_cmp_lt_u32 s22, 64
    s_cbranch_scc1 F_FB1

    v_mov_b32 v27, v26
    s_nop 1
    v_permlane32_swap_b32 v26, v27
    s_nop 1
    v_max_f32 v26, v26, v27

    v_sub_f32 v26, 0, v26
    v_mov_b32 v32, v26
    v_mov_b32 v80, 0
    v_mov_b32 v33, v26
    v_mov_b32 v81, 0
    v_mov_b32 v34, v26
    v_mov_b32 v82, 0
    v_mov_b32 v35, v26
    v_mov_b32 v83, 0
    v_mov_b32 v36, v26
    v_mov_b32 v84, 0
    v_mov_b32 v37, v26
    v_mov_b32 v85, 0
    v_mov_b32 v38, v26
    v_mov_b32 v86, 0
    v_mov_b32 v39, v26
    v_mov_b32 v87, 0
    v_mov_b32 v40, v26
    v_mov_b32 v88, 0
    v_mov_b32 v41, v26
    v_mov_b32 v89, 0
    v_mov_b32 v42, v26
    v_mov_b32 v90, 0
    v_mov_b32 v43, v26
    v_mov_b32 v91, 0
    v_mov_b32 v44, v26
    v_mov_b32 v92, 0
    v_mov_b32 v45, v26
    v_mov_b32 v93, 0
    v_mov_b32 v46, v26
    v_mov_b32 v94, 0
    v_mov_b32 v47, v26
    v_mov_b32 v95, 0
    s_mov_b32 s22, 0
F_FB2:
    s_lshl_b32 s21, s22, 10
    s_add_u32 s25, s21, s23
    buffer_load_dwordx4 v[12:15], v1, s[16:19], s25 offen sc0 sc1
    s_add_u32 s25, s21, s24
    s_mov_b64 exec, s[54:55]
    buffer_load_dwordx4 v[16:19], v25, s[16:19], s25 offen sc0 sc1
    buffer_load_dwordx4 v[20:23], v25, s[16:19], s25 offen offset:512 sc0 sc1
    s_mov_b64 exec, -1
    s_waitcnt vmcnt(0)
    v_mfma_f32_32x32x16_bf16 v[48:63], v[12:15], v[4:7], v[32:47]
    s_nop 15

    v_exp_f32 v48, v48
    v_exp_f32 v49, v49
    v_exp_f32 v50, v50
    v_exp_f32 v51, v51
    v_exp_f32 v52, v52
    v_exp_f32 v53, v53
    v_exp_f32 v54, v54
    v_exp_f32 v55, v55
    v_exp_f32 v56, v56
    v_exp_f32 v57, v57
    v_exp_f32 v58, v58
    v_exp_f32 v59, v59
    v_exp_f32 v60, v60
    v_exp_f32 v61, v61
    v_exp_f32 v62, v62
    v_exp_f32 v63, v63
    s_nop 1
    v_smfmac_f32_32x32x32_bf16 v[80:95], v[16:19], v[48:55], v24
    v_smfmac_f32_32x32x32_bf16 v[80:95], v[20:23], v[56:63], v24
    s_add_u32 s22, s22, 1
    s_cmp_lt_u32 s22, 64
    s_cbranch_scc1 F_FB2
    s_nop 15
    s_branch F_FB_RET
F_DONE:
    s_endpgm

.section .rodata,"a"
.p2align 6
.amdhsa_kernel concat_heads__mha_block__sliding_local_dilated__prompt_kernel
  .amdhsa_next_free_vgpr 256
  .amdhsa_next_free_sgpr 100
  .amdhsa_accum_offset 256
  .amdhsa_group_segment_fixed_size 0
  .amdhsa_kernarg_size 72
  .amdhsa_user_sgpr_count 2
  .amdhsa_user_sgpr_kernarg_segment_ptr 1
  .amdhsa_system_sgpr_workgroup_id_x 1
  .amdhsa_float_denorm_mode_32 3
.end_amdhsa_kernel
```
